```python
import torch

def _softmax(x, axis=-1):
    return torch.softmax(x, dim=axis)

def _gelu(x):
    return torch.nn.functional.gelu(x, approximate='tanh')

def _silu(x):
    return torch.nn.functional.silu(x)

def _sigmoid(x):
    return torch.sigmoid(x)

def _layernorm(x, axis=-1, eps=1e-05):
    m = x.mean(dim=axis, keepdim=True)
    v = x.var(dim=axis, keepdim=True, unbiased=False)
    return (x - m) / torch.sqrt(v + eps)

def _scatter_add(tgt, idx, src, axis=0):
    return tgt.clone().index_add_(axis, idx, src)

def _segment_sum(src, seg, n):
    out = torch.zeros((n,) + src.shape[1:], dtype=src.dtype)
    return out.index_add_(0, seg, src)

def _pad(x, pw):
    flat = tuple((v for pair in reversed(pw) for v in pair))
    return torch.nn.functional.pad(x, flat)
kernel_name = 'standalone__tree_speculative_verify_tree_attention_over_candidate_token_tree__decode'

def setup_inputs():

    _w = lambda a: (lambda t: t.to(torch.bfloat16) if t.is_floating_point() else t)(torch.as_tensor(a))
    B, Hq, Hkv, T, C, D = (2, 32, 16, 1, 4096, 128)
    tree_mask = torch.zeros((B, T, T), dtype=float)
    for b in range(B):
        parent = torch.zeros(T, dtype=torch.int64)
        for i in range(1, T):
            parent[i] = int(torch.randint(0, i, (1,)).item())
        for i in range(T):
            j = i
            tree_mask[b, i, j] = 1.0
            while j > 0:
                j = parent[j]
                tree_mask[b, i, j] = 1.0
    return {'q': _w((lambda *s: torch.randn(*s, dtype=torch.bfloat16) * 0.8)(B, Hq, T, D)), 'k_cache': _w((lambda *s: torch.randn(*s, dtype=torch.bfloat16) * 0.8)(B, Hkv, C, D)), 'v_cache': _w((lambda *s: torch.randn(*s, dtype=torch.bfloat16) * 0.05)(B, Hkv, C, D)), 'k_tree': _w((lambda *s: torch.randn(*s, dtype=torch.bfloat16) * 0.8)(B, Hkv, T, D)), 'v_tree': _w((lambda *s: torch.randn(*s, dtype=torch.bfloat16) * 0.05)(B, Hkv, T, D)), 'tree_mask': _w(tree_mask)}

def reference(q, k_cache, v_cache, k_tree, v_tree, tree_mask):
    B, Hq, T, D = q.shape
    Hkv, C = (k_cache.shape[1], k_cache.shape[2])
    rep = Hq // Hkv
    kc = (lambda x, n, axis: torch.repeat_interleave(x, n, dim=axis))(k_cache, rep, axis=1)
    vc = (lambda x, n, axis: torch.repeat_interleave(x, n, dim=axis))(v_cache, rep, axis=1)
    kt = (lambda x, n, axis: torch.repeat_interleave(x, n, dim=axis))(k_tree, rep, axis=1)
    vt = (lambda x, n, axis: torch.repeat_interleave(x, n, dim=axis))(v_tree, rep, axis=1)
    k = torch.concatenate([kc, kt], axis=2)
    v = torch.concatenate([vc, vt], axis=2)
    scale = D ** (-0.5)
    scores = torch.einsum('bhqd,bhkd->bhqk', q, k) * scale
    ctx_mask = torch.ones((B, 1, T, C), dtype=scores.dtype)
    tm = tree_mask[:, None, :, :].clone()
    full_mask = torch.concatenate([ctx_mask, tm], axis=-1)
    scores = scores + (1.0 - full_mask) * -1000000000.0
    p = _softmax(scores, axis=-1)
    return torch.einsum('bhqk,bhkd->bhqd', p, v)
```

```asm
; @launch grid=(256,1,1) block=(64,1,1) lds=0
.amdgcn_target "amdgcn-amd-amdhsa--gfx950"
.text
.globl standalone__tree_speculative_verify_tree_attention_over_candidate_token_tree__decode_kernel
.p2align 8
.type standalone__tree_speculative_verify_tree_attention_over_candidate_token_tree__decode_kernel,@function
standalone__tree_speculative_verify_tree_attention_over_candidate_token_tree__decode_kernel:
    s_load_dwordx2 s[24:25], s[0:1], 8
    s_load_dwordx2 s[32:33], s[0:1], 0
    s_load_dwordx2 s[48:49], s[0:1], 64
    s_load_dwordx2 s[28:29], s[0:1], 16
    s_load_dwordx2 s[52:53], s[0:1], 56
    s_load_dwordx2 s[44:45], s[0:1], 48
    s_cmp_ge_u32 s2, 256
    s_cbranch_scc1 L_exit
    s_getpc_b64 s[8:9]
L_pc:
    s_lshr_b32 s4, s2, 3
    s_and_b32 s4, s4, 15
    s_mul_i32 s4, s4, 1024
    s_addk_i32 s4, 768
    v_lshl_add_u32 v1, v0, 7, s4
    v_min_u32 v1, L_notready-L_pc, v1
    s_mov_b64 exec, 0xff
    global_load_dword v99, v1, s[8:9]
    s_mov_b64 exec, -1
    v_and_b32 v7, 48, v0
    v_lshlrev_b32 v6, 2, v7
    v_and_b32 v4, 3, v0
    v_lshl_or_b32 v7, v4, 4, v6
    v_and_b32 v5, 12, v0
    s_bitcmp1_b32 s2, 0
    s_cselect_b32 s60, 0x198c00, 0
    s_bitcmp1_b32 s2, 1
    s_cselect_b32 s4, 0x212700, 0
    s_xor_b32 s60, s60, s4
    s_bitcmp1_b32 s2, 2
    s_cselect_b32 s4, 0x455c00, 0
    s_xor_b32 s60, s60, s4
    s_bitcmp1_b32 s2, 3
    s_cselect_b32 s4, 0x8b6700, 0
    s_xor_b32 s60, s60, s4
    s_bitcmp1_b32 s2, 4
    s_cselect_b32 s4, 0x1017c00, 0
    s_xor_b32 s60, s60, s4
    s_bitcmp1_b32 s2, 5
    s_cselect_b32 s4, 0xa900, 0
    s_xor_b32 s60, s60, s4
    s_bitcmp1_b32 s2, 6
    s_cselect_b32 s4, 0x4800, 0
    s_xor_b32 s60, s60, s4
    s_bitcmp1_b32 s2, 7
    s_cselect_b32 s4, 0xd500, 0
    s_xor_b32 s60, s60, s4
    s_mov_b32 s62, 0xb000
    s_mov_b32 s63, 0xe700
    s_mov_b32 s64, 0x4c00
    s_mov_b32 s65, 0x5d000
    s_mov_b32 s66, 0x1d800
    s_mov_b32 s67, 0xb9a00
    s_mov_b32 s68, 0x86400
    v_xor_b32 v2, s60, v7
    v_bfe_i32 v36, v0, 2, 1
    v_and_b32 v36, 0x8300, v36
    v_xor_b32 v2, v36, v2
    v_bfe_i32 v36, v0, 3, 1
    v_and_b32 v36, 0x1a800, v36
    v_xor_b32 v2, v36, v2
    s_mov_b32 s26, 33554432
    s_mov_b32 s27, 0x20000
    v_lshl_or_b32 v4, v5, 2, v6
    v_and_b32 v5, 2, v0
    v_lshl_or_b32 v4, v5, 7, v4
    v_lshlrev_b32 v3, 4, v0
    s_lshr_b32 s22, s60, 20
    s_lshr_b32 s23, s2, 5
    s_lshl_b32 s5, s22, 9
    s_mov_b32 s34, 16384
    s_mov_b32 s35, 0x20000
    s_mov_b32 s50, 8388608
    s_mov_b32 s51, 0x20000
    s_lshl_b32 s12, s22, 15
    s_lshl_b32 s6, s22, 7
    s_add_u32 s6, s6, 2097152
    v_mov_b32 v60, -1
    v_mov_b32 v61, -1
    v_mov_b32 v62, -1
    v_mov_b32 v63, -1
    s_waitcnt lgkmcnt(0)
    buffer_load_dwordx4 a[0:3], v2, s[24:27], 0 offen nt
    v_xor_b32 v2, s62, v2
    s_load_dwordx2 s[36:37], s[0:1], 24
    s_load_dwordx2 s[40:41], s[0:1], 32
    s_load_dwordx2 s[54:55], s[0:1], 40
    buffer_load_dwordx4 a[4:7], v2, s[24:27], 0 offen nt
    v_xor_b32 v2, s63, v2
    buffer_load_dwordx4 v[8:11], v4, s[32:35], s5 offen
    buffer_load_dwordx4 a[8:11], v2, s[24:27], 0 offen nt
    v_xor_b32 v2, s62, v2
    s_cmp_lg_u32 s23, 0
    s_cbranch_scc1 L_noclear
    s_mov_b64 exec, 0xff
    buffer_store_dwordx4 v[60:63], v3, s[48:51], s6 offen
    s_mov_b64 exec, -1
L_noclear:
    buffer_load_dwordx4 a[12:15], v2, s[24:27], 0 offen nt
    v_xor_b32 v2, s64, v2
    buffer_load_dwordx4 a[16:19], v2, s[24:27], 0 offen nt
    v_xor_b32 v2, s62, v2
    buffer_load_dwordx4 a[20:23], v2, s[24:27], 0 offen nt
    v_xor_b32 v2, s63, v2
    buffer_load_dwordx4 a[24:27], v2, s[24:27], 0 offen nt
    v_xor_b32 v2, s62, v2
    buffer_load_dwordx4 a[28:31], v2, s[24:27], 0 offen nt
    v_xor_b32 v2, s65, v2
    s_cmp_lg_u32 s23, 2
    s_cbranch_scc1 L_notree0
    s_mov_b32 s38, 8192
    s_mov_b32 s39, 0x20000
    s_mov_b32 s42, 8192
    s_mov_b32 s43, 0x20000
    s_lshl_b32 s4, s22, 8
    v_and_b32 v36, 0xf0, v3
    s_waitcnt lgkmcnt(0)
    s_load_dword s56, s[54:55], 0
    buffer_load_dwordx4 v[44:47], v7, s[36:39], s4 offen
    buffer_load_dwordx4 v[48:51], v36, s[40:43], s4 offen
L_notree0:
    buffer_load_dwordx4 a[32:35], v2, s[24:27], 0 offen nt
    v_xor_b32 v2, s62, v2
    buffer_load_dwordx4 a[36:39], v2, s[24:27], 0 offen nt
    v_xor_b32 v2, s63, v2
    buffer_load_dwordx4 a[40:43], v2, s[24:27], 0 offen nt
    v_xor_b32 v2, s62, v2
    buffer_load_dwordx4 a[44:47], v2, s[24:27], 0 offen nt
    v_xor_b32 v2, s64, v2
    buffer_load_dwordx4 a[48:51], v2, s[24:27], 0 offen nt
    v_xor_b32 v2, s62, v2
    buffer_load_dwordx4 a[52:55], v2, s[24:27], 0 offen nt
    v_xor_b32 v2, s63, v2
    buffer_load_dwordx4 a[56:59], v2, s[24:27], 0 offen nt
    v_xor_b32 v2, s62, v2
    buffer_load_dwordx4 a[60:63], v2, s[24:27], 0 offen nt
    v_xor_b32 v2, s66, v2
    buffer_load_dwordx4 a[64:67], v2, s[24:27], 0 offen nt
    v_xor_b32 v2, s62, v2
    buffer_load_dwordx4 a[68:71], v2, s[24:27], 0 offen nt
    v_xor_b32 v2, s63, v2
    buffer_load_dwordx4 a[72:75], v2, s[24:27], 0 offen nt
    v_xor_b32 v2, s62, v2
    buffer_load_dwordx4 a[76:79], v2, s[24:27], 0 offen nt
    v_xor_b32 v2, s64, v2
    buffer_load_dwordx4 a[80:83], v2, s[24:27], 0 offen nt
    v_xor_b32 v2, s62, v2
    buffer_load_dwordx4 a[84:87], v2, s[24:27], 0 offen nt
    v_xor_b32 v2, s63, v2
    buffer_load_dwordx4 a[88:91], v2, s[24:27], 0 offen nt
    v_xor_b32 v2, s62, v2
    buffer_load_dwordx4 a[92:95], v2, s[24:27], 0 offen nt
    v_xor_b32 v2, s65, v2
    buffer_load_dwordx4 a[96:99], v2, s[24:27], 0 offen nt
    v_xor_b32 v2, s62, v2
    buffer_load_dwordx4 a[100:103], v2, s[24:27], 0 offen nt
    v_xor_b32 v2, s63, v2
    buffer_load_dwordx4 a[104:107], v2, s[24:27], 0 offen nt
    v_xor_b32 v2, s62, v2
    buffer_load_dwordx4 a[108:111], v2, s[24:27], 0 offen nt
    v_xor_b32 v2, s64, v2
    buffer_load_dwordx4 a[112:115], v2, s[24:27], 0 offen nt
    v_xor_b32 v2, s62, v2
    buffer_load_dwordx4 a[116:119], v2, s[24:27], 0 offen nt
    v_xor_b32 v2, s63, v2
    buffer_load_dwordx4 a[120:123], v2, s[24:27], 0 offen nt
    v_xor_b32 v2, s62, v2
    buffer_load_dwordx4 a[124:127], v2, s[24:27], 0 offen nt
    v_xor_b32 v2, s67, v2
    buffer_load_dwordx4 a[128:131], v2, s[24:27], 0 offen nt
    v_xor_b32 v2, s62, v2
    buffer_load_dwordx4 a[132:135], v2, s[24:27], 0 offen nt
    v_xor_b32 v2, s63, v2
    buffer_load_dwordx4 a[136:139], v2, s[24:27], 0 offen nt
    v_xor_b32 v2, s62, v2
    buffer_load_dwordx4 a[140:143], v2, s[24:27], 0 offen nt
    v_xor_b32 v2, s64, v2
    buffer_load_dwordx4 a[144:147], v2, s[24:27], 0 offen nt
    v_xor_b32 v2, s62, v2
    buffer_load_dwordx4 a[148:151], v2, s[24:27], 0 offen nt
    v_xor_b32 v2, s63, v2
    buffer_load_dwordx4 a[152:155], v2, s[24:27], 0 offen nt
    v_xor_b32 v2, s62, v2
    buffer_load_dwordx4 a[156:159], v2, s[24:27], 0 offen nt
    v_xor_b32 v2, s65, v2
    buffer_load_dwordx4 a[160:163], v2, s[24:27], 0 offen nt
    v_xor_b32 v2, s62, v2
    buffer_load_dwordx4 a[164:167], v2, s[24:27], 0 offen nt
    v_xor_b32 v2, s63, v2
    s_mov_b32 s30, 33554432
    s_mov_b32 s31, 0x20000
    s_mov_b32 s46, 16384
    s_mov_b32 s47, 0x20000
    v_and_b32 v103, 0xf0, v3
    v_xor_b32 v103, s60, v103
    v_bfe_i32 v36, v0, 4, 1
    v_and_b32 v36, 0x8300, v36
    v_xor_b32 v103, v36, v103
    v_bfe_i32 v36, v0, 5, 1
    v_and_b32 v36, 0x1a800, v36
    v_xor_b32 v103, v36, v103
    v_and_b32 v36, 1, v0
    v_lshlrev_b32 v38, 4, v36
    v_mov_b32 v37, 0xffff
    v_lshlrev_b32 v37, v38, v37
    v_mov_b32 v12, 0
    v_mov_b32 v13, 0
    v_mov_b32 v14, 0
    v_mov_b32 v15, 0
    v_mov_b32 v16, 0
    v_mov_b32 v17, 0
    v_mov_b32 v18, 0
    v_mov_b32 v19, 0
    v_mov_b32_dpp v12, v37 quad_perm:[0,1,2,3] row_mask:0xf bank_mask:0x1
    v_mov_b32_dpp v13, v37 quad_perm:[0,1,2,3] row_mask:0xf bank_mask:0x2
    v_mov_b32_dpp v14, v37 quad_perm:[0,1,2,3] row_mask:0xf bank_mask:0x4
    v_mov_b32_dpp v15, v37 quad_perm:[0,1,2,3] row_mask:0xf bank_mask:0x8
    v_mov_b32 v96, 0xff800000
    s_mov_b32 s8, 0x3e0293ee
    s_getreg_b32 s16, hwreg(HW_REG_XCC_ID, 0, 4)
    s_or_b32 s16, s16, 0x100
    s_lshl_b32 s18, s22, 2
    s_lshl_b32 s13, s23, 10
    s_add_u32 s13, s13, s12
    s_and_b32 s15, s23, 4
    s_lshl_b32 s15, s15, 4
    s_add_u32 s15, s15, s6
    s_lshl_b32 s20, s23, 6
    s_add_u32 s20, s20, s5
    s_lshl_b32 s14, s23, 7
    s_add_u32 s14, s14, s12
    s_lshl_b32 s9, s23, 3
    s_add_u32 s9, s9, s6
    s_mov_b32 s21, 262144
    s_mov_b32 s11, 0
    s_mov_b32 s70, 0x00ff00ff
    s_mov_b32 s71, 0x00ff00ff
    v_lshlrev_b32 v1, 11, v5
    v_lshl_or_b32 v1, v6, 4, v1
    v_and_b32 v6, 12, v0
    v_lshl_or_b32 v1, v6, 3, v1
    v_or_b32 v1, v38, v1
    v_lshlrev_b32 v5, 5, v5
    v_and_b32 v6, 56, v0
    v_and_b32 v36, 7, v0
    v_lshlrev_b32 v36, 1, v36
    v_lshrrev_b32 v37, 5, v0
    v_lshl_or_b32 v36, v37, 4, v36
    v_and_b32 v37, 16, v0
    v_lshl_or_b32 v102, v37, 1, v36
    s_waitcnt vmcnt(39)
    v_mfma_f32_16x16x32_bf16 v[20:23], a[0:3], v[8:11], 0
    buffer_load_dwordx4 a[0:3], v2, s[24:27], 0 offen nt
    v_xor_b32 v2, s62, v2
    s_waitcnt vmcnt(40)
    v_mfma_f32_16x16x32_bf16 v[24:27], a[4:7], v[8:11], 0
    buffer_load_dwordx4 a[4:7], v2, s[24:27], 0 offen nt
    v_xor_b32 v2, s64, v2
    s_waitcnt vmcnt(41)
    v_mfma_f32_16x16x32_bf16 v[28:31], a[8:11], v[8:11], 0
    buffer_load_dwordx4 a[8:11], v2, s[24:27], 0 offen nt
    v_xor_b32 v2, s62, v2
    v_add_f32_dpp v20, v21, v20 row_ror:12 row_mask:0xf bank_mask:0xf
    v_add_f32_dpp v22, v23, v22 row_ror:12 row_mask:0xf bank_mask:0xf
    s_waitcnt vmcnt(41)
    v_mfma_f32_16x16x32_bf16 v[32:35], a[12:15], v[8:11], 0
    buffer_load_dwordx4 a[12:15], v2, s[24:27], 0 offen nt
    v_xor_b32 v2, s63, v2
    s_cmp_lg_u32 s23, 0
    s_cbranch_scc1 L_nosig
    s_atomic_or s16, s[52:53], s18
L_nosig:
    v_add_f32_dpp v64, v22, v20 row_ror:8 row_mask:0xf bank_mask:0x1
    v_add_f32_dpp v25, v26, v25 row_ror:12 row_mask:0xf bank_mask:0xf
    v_add_f32_dpp v27, v24, v27 row_ror:12 row_mask:0xf bank_mask:0xf
    s_waitcnt vmcnt(41)
    v_mfma_f32_16x16x32_bf16 v[20:23], a[16:19], v[8:11], 0
    buffer_load_dwordx4 a[16:19], v2, s[24:27], 0 offen nt
    v_xor_b32 v2, s62, v2
    v_add_f32_dpp v64, v27, v25 row_ror:8 row_mask:0xf bank_mask:0x2
    v_add_f32_dpp v30, v31, v30 row_ror:12 row_mask:0xf bank_mask:0xf
    v_add_f32_dpp v28, v29, v28 row_ror:12 row_mask:0xf bank_mask:0xf
    s_waitcnt vmcnt(41)
    v_mfma_f32_16x16x32_bf16 v[24:27], a[20:23], v[8:11], 0
    buffer_load_dwordx4 a[20:23], v2, s[24:27], 0 offen nt
    v_xor_b32 v2, s66, v2
    v_add_f32_dpp v64, v28, v30 row_ror:8 row_mask:0xf bank_mask:0x4
    v_add_f32_dpp v35, v32, v35 row_ror:12 row_mask:0xf bank_mask:0xf
    v_add_f32_dpp v33, v34, v33 row_ror:12 row_mask:0xf bank_mask:0xf
    s_waitcnt vmcnt(41)
    v_mfma_f32_16x16x32_bf16 v[28:31], a[24:27], v[8:11], 0
    buffer_load_dwordx4 a[24:27], v2, s[24:27], 0 offen nt
    v_xor_b32 v2, s62, v2
    v_add_f32_dpp v64, v33, v35 row_ror:8 row_mask:0xf bank_mask:0x8
    v_add_f32_dpp v20, v21, v20 row_ror:12 row_mask:0xf bank_mask:0xf
    v_add_f32_dpp v22, v23, v22 row_ror:12 row_mask:0xf bank_mask:0xf
    s_waitcnt vmcnt(41)
    v_mfma_f32_16x16x32_bf16 v[32:35], a[28:31], v[8:11], 0
    buffer_load_dwordx4 a[28:31], v2, s[24:27], 0 offen nt
    v_xor_b32 v2, s63, v2
    v_add_f32_dpp v65, v22, v20 row_ror:8 row_mask:0xf bank_mask:0x1
    v_add_f32_dpp v25, v26, v25 row_ror:12 row_mask:0xf bank_mask:0xf
    v_add_f32_dpp v27, v24, v27 row_ror:12 row_mask:0xf bank_mask:0xf
    s_waitcnt vmcnt(41)
    v_mfma_f32_16x16x32_bf16 v[20:23], a[32:35], v[8:11], 0
    buffer_load_dwordx4 a[32:35], v2, s[24:27], 0 offen nt
    v_xor_b32 v2, s62, v2
    v_add_f32_dpp v65, v27, v25 row_ror:8 row_mask:0xf bank_mask:0x2
    v_add_f32_dpp v30, v31, v30 row_ror:12 row_mask:0xf bank_mask:0xf
    v_add_f32_dpp v28, v29, v28 row_ror:12 row_mask:0xf bank_mask:0xf
    s_waitcnt vmcnt(41)
    v_mfma_f32_16x16x32_bf16 v[24:27], a[36:39], v[8:11], 0
    buffer_load_dwordx4 a[36:39], v2, s[24:27], 0 offen nt
    v_xor_b32 v2, s64, v2
    v_add_f32_dpp v65, v28, v30 row_ror:8 row_mask:0xf bank_mask:0x4
    v_add_f32_dpp v35, v32, v35 row_ror:12 row_mask:0xf bank_mask:0xf
    v_add_f32_dpp v33, v34, v33 row_ror:12 row_mask:0xf bank_mask:0xf
    s_waitcnt vmcnt(41)
    v_mfma_f32_16x16x32_bf16 v[28:31], a[40:43], v[8:11], 0
    buffer_load_dwordx4 a[40:43], v2, s[24:27], 0 offen nt
    v_xor_b32 v2, s62, v2
    v_add_f32_dpp v65, v33, v35 row_ror:8 row_mask:0xf bank_mask:0x8
    v_add_f32_dpp v20, v21, v20 row_ror:12 row_mask:0xf bank_mask:0xf
    v_add_f32_dpp v22, v23, v22 row_ror:12 row_mask:0xf bank_mask:0xf
    s_waitcnt vmcnt(41)
    v_mfma_f32_16x16x32_bf16 v[32:35], a[44:47], v[8:11], 0
    buffer_load_dwordx4 a[44:47], v2, s[24:27], 0 offen nt
    v_xor_b32 v2, s63, v2
    v_add_f32_dpp v66, v22, v20 row_ror:8 row_mask:0xf bank_mask:0x1
    v_add_f32_dpp v25, v26, v25 row_ror:12 row_mask:0xf bank_mask:0xf
    v_add_f32_dpp v27, v24, v27 row_ror:12 row_mask:0xf bank_mask:0xf
    s_waitcnt vmcnt(41)
    v_mfma_f32_16x16x32_bf16 v[20:23], a[48:51], v[8:11], 0
    buffer_load_dwordx4 a[48:51], v2, s[24:27], 0 offen nt
    v_xor_b32 v2, s62, v2
    v_add_f32_dpp v66, v27, v25 row_ror:8 row_mask:0xf bank_mask:0x2
    v_max_f32 v97, v64, v65
    v_add_f32_dpp v30, v31, v30 row_ror:12 row_mask:0xf bank_mask:0xf
    v_add_f32_dpp v28, v29, v28 row_ror:12 row_mask:0xf bank_mask:0xf
    s_waitcnt vmcnt(41)
    v_mfma_f32_16x16x32_bf16 v[24:27], a[52:55], v[8:11], 0
    buffer_load_dwordx4 a[52:55], v2, s[24:27], 0 offen nt
    v_xor_b32 v2, s65, v2
    v_add_f32_dpp v66, v28, v30 row_ror:8 row_mask:0xf bank_mask:0x4
    v_add_f32_dpp v35, v32, v35 row_ror:12 row_mask:0xf bank_mask:0xf
    v_add_f32_dpp v33, v34, v33 row_ror:12 row_mask:0xf bank_mask:0xf
    s_waitcnt vmcnt(41)
    v_mfma_f32_16x16x32_bf16 v[28:31], a[56:59], v[8:11], 0
    buffer_load_dwordx4 a[56:59], v2, s[24:27], 0 offen nt
    v_xor_b32 v2, s62, v2
    v_add_f32_dpp v66, v33, v35 row_ror:8 row_mask:0xf bank_mask:0x8
    v_add_f32_dpp v20, v21, v20 row_ror:12 row_mask:0xf bank_mask:0xf
    v_add_f32_dpp v22, v23, v22 row_ror:12 row_mask:0xf bank_mask:0xf
    s_waitcnt vmcnt(41)
    v_mfma_f32_16x16x32_bf16 v[32:35], a[60:63], v[8:11], 0
    buffer_load_dwordx4 a[60:63], v2, s[24:27], 0 offen nt
    v_xor_b32 v2, s63, v2
    v_add_f32_dpp v67, v22, v20 row_ror:8 row_mask:0xf bank_mask:0x1
    v_add_f32_dpp v25, v26, v25 row_ror:12 row_mask:0xf bank_mask:0xf
    v_add_f32_dpp v27, v24, v27 row_ror:12 row_mask:0xf bank_mask:0xf
    s_waitcnt vmcnt(41)
    v_mfma_f32_16x16x32_bf16 v[20:23], a[64:67], v[8:11], 0
    buffer_load_dwordx4 a[64:67], v2, s[24:27], 0 offen nt
    v_xor_b32 v2, s62, v2
    v_add_f32_dpp v67, v27, v25 row_ror:8 row_mask:0xf bank_mask:0x2
    v_add_f32_dpp v30, v31, v30 row_ror:12 row_mask:0xf bank_mask:0xf
    v_add_f32_dpp v28, v29, v28 row_ror:12 row_mask:0xf bank_mask:0xf
    s_waitcnt vmcnt(41)
    v_mfma_f32_16x16x32_bf16 v[24:27], a[68:71], v[8:11], 0
    buffer_load_dwordx4 a[68:71], v2, s[24:27], 0 offen nt
    v_xor_b32 v2, s64, v2
    v_add_f32_dpp v67, v28, v30 row_ror:8 row_mask:0xf bank_mask:0x4
    v_add_f32_dpp v35, v32, v35 row_ror:12 row_mask:0xf bank_mask:0xf
    v_add_f32_dpp v33, v34, v33 row_ror:12 row_mask:0xf bank_mask:0xf
    s_waitcnt vmcnt(41)
    v_mfma_f32_16x16x32_bf16 v[28:31], a[72:75], v[8:11], 0
    buffer_load_dwordx4 a[72:75], v2, s[24:27], 0 offen nt
    v_xor_b32 v2, s62, v2
    v_add_f32_dpp v67, v33, v35 row_ror:8 row_mask:0xf bank_mask:0x8
    v_add_f32_dpp v20, v21, v20 row_ror:12 row_mask:0xf bank_mask:0xf
    v_add_f32_dpp v22, v23, v22 row_ror:12 row_mask:0xf bank_mask:0xf
    s_waitcnt vmcnt(41)
    v_mfma_f32_16x16x32_bf16 v[32:35], a[76:79], v[8:11], 0
    buffer_load_dwordx4 a[76:79], v2, s[24:27], 0 offen nt
    v_xor_b32 v2, s63, v2
    v_add_f32_dpp v68, v22, v20 row_ror:8 row_mask:0xf bank_mask:0x1
    v_add_f32_dpp v25, v26, v25 row_ror:12 row_mask:0xf bank_mask:0xf
    v_add_f32_dpp v27, v24, v27 row_ror:12 row_mask:0xf bank_mask:0xf
    s_waitcnt vmcnt(41)
    v_mfma_f32_16x16x32_bf16 v[20:23], a[80:83], v[8:11], 0
    buffer_load_dwordx4 a[80:83], v2, s[24:27], 0 offen nt
    v_xor_b32 v2, s62, v2
    v_add_f32_dpp v68, v27, v25 row_ror:8 row_mask:0xf bank_mask:0x2
    v_max3_f32 v97, v97, v66, v67
    v_add_f32_dpp v30, v31, v30 row_ror:12 row_mask:0xf bank_mask:0xf
    v_add_f32_dpp v28, v29, v28 row_ror:12 row_mask:0xf bank_mask:0xf
    s_waitcnt vmcnt(41)
    v_mfma_f32_16x16x32_bf16 v[24:27], a[84:87], v[8:11], 0
    buffer_load_dwordx4 a[84:87], v2, s[24:27], 0 offen nt
    v_xor_b32 v2, s68, v2
    v_add_f32_dpp v68, v28, v30 row_ror:8 row_mask:0xf bank_mask:0x4
    v_add_f32_dpp v35, v32, v35 row_ror:12 row_mask:0xf bank_mask:0xf
    v_add_f32_dpp v33, v34, v33 row_ror:12 row_mask:0xf bank_mask:0xf
    s_waitcnt vmcnt(41)
    v_mfma_f32_16x16x32_bf16 v[28:31], a[88:91], v[8:11], 0
    buffer_load_dwordx4 a[88:91], v2, s[24:27], 0 offen nt
    v_xor_b32 v2, s62, v2
    v_add_f32_dpp v68, v33, v35 row_ror:8 row_mask:0xf bank_mask:0x8
    v_add_f32_dpp v20, v21, v20 row_ror:12 row_mask:0xf bank_mask:0xf
    v_add_f32_dpp v22, v23, v22 row_ror:12 row_mask:0xf bank_mask:0xf
    s_waitcnt vmcnt(41)
    v_mfma_f32_16x16x32_bf16 v[32:35], a[92:95], v[8:11], 0
    buffer_load_dwordx4 a[92:95], v2, s[24:27], 0 offen nt
    v_xor_b32 v2, s63, v2
    v_add_f32_dpp v69, v22, v20 row_ror:8 row_mask:0xf bank_mask:0x1
    v_add_f32_dpp v25, v26, v25 row_ror:12 row_mask:0xf bank_mask:0xf
    v_add_f32_dpp v27, v24, v27 row_ror:12 row_mask:0xf bank_mask:0xf
    s_waitcnt vmcnt(41)
    v_mfma_f32_16x16x32_bf16 v[20:23], a[96:99], v[8:11], 0
    buffer_load_dwordx4 a[96:99], v2, s[24:27], 0 offen nt
    v_xor_b32 v2, s62, v2
    v_add_f32_dpp v69, v27, v25 row_ror:8 row_mask:0xf bank_mask:0x2
    v_add_f32_dpp v30, v31, v30 row_ror:12 row_mask:0xf bank_mask:0xf
    v_add_f32_dpp v28, v29, v28 row_ror:12 row_mask:0xf bank_mask:0xf
    s_waitcnt vmcnt(41)
    v_mfma_f32_16x16x32_bf16 v[24:27], a[100:103], v[8:11], 0
    buffer_load_dwordx4 a[100:103], v2, s[24:27], 0 offen nt
    v_xor_b32 v2, s64, v2
    v_add_f32_dpp v69, v28, v30 row_ror:8 row_mask:0xf bank_mask:0x4
    v_add_f32_dpp v35, v32, v35 row_ror:12 row_mask:0xf bank_mask:0xf
    v_add_f32_dpp v33, v34, v33 row_ror:12 row_mask:0xf bank_mask:0xf
    s_waitcnt vmcnt(41)
    v_mfma_f32_16x16x32_bf16 v[28:31], a[104:107], v[8:11], 0
    buffer_load_dwordx4 a[104:107], v2, s[24:27], 0 offen nt
    v_xor_b32 v2, s62, v2
    v_add_f32_dpp v69, v33, v35 row_ror:8 row_mask:0xf bank_mask:0x8
    v_add_f32_dpp v20, v21, v20 row_ror:12 row_mask:0xf bank_mask:0xf
    v_add_f32_dpp v22, v23, v22 row_ror:12 row_mask:0xf bank_mask:0xf
    s_waitcnt vmcnt(41)
    v_mfma_f32_16x16x32_bf16 v[32:35], a[108:111], v[8:11], 0
    buffer_load_dwordx4 a[108:111], v2, s[24:27], 0 offen nt
    v_xor_b32 v2, s63, v2
    v_add_f32_dpp v70, v22, v20 row_ror:8 row_mask:0xf bank_mask:0x1
    v_add_f32_dpp v25, v26, v25 row_ror:12 row_mask:0xf bank_mask:0xf
    v_add_f32_dpp v27, v24, v27 row_ror:12 row_mask:0xf bank_mask:0xf
    s_waitcnt vmcnt(41)
    v_mfma_f32_16x16x32_bf16 v[20:23], a[112:115], v[8:11], 0
    buffer_load_dwordx4 a[112:115], v2, s[24:27], 0 offen nt
    v_xor_b32 v2, s62, v2
    v_add_f32_dpp v70, v27, v25 row_ror:8 row_mask:0xf bank_mask:0x2
    v_max3_f32 v97, v97, v68, v69
    v_add_f32_dpp v30, v31, v30 row_ror:12 row_mask:0xf bank_mask:0xf
    v_add_f32_dpp v28, v29, v28 row_ror:12 row_mask:0xf bank_mask:0xf
    s_waitcnt vmcnt(41)
    v_mfma_f32_16x16x32_bf16 v[24:27], a[116:119], v[8:11], 0
    buffer_load_dwordx4 a[116:119], v2, s[24:27], 0 offen nt
    v_xor_b32 v2, s65, v2
    v_add_f32_dpp v70, v28, v30 row_ror:8 row_mask:0xf bank_mask:0x4
    v_add_f32_dpp v35, v32, v35 row_ror:12 row_mask:0xf bank_mask:0xf
    v_add_f32_dpp v33, v34, v33 row_ror:12 row_mask:0xf bank_mask:0xf
    s_waitcnt vmcnt(41)
    v_mfma_f32_16x16x32_bf16 v[28:31], a[120:123], v[8:11], 0
    buffer_load_dwordx4 a[120:123], v2, s[24:27], 0 offen nt
    v_xor_b32 v2, s62, v2
    v_add_f32_dpp v70, v33, v35 row_ror:8 row_mask:0xf bank_mask:0x8
    v_add_f32_dpp v20, v21, v20 row_ror:12 row_mask:0xf bank_mask:0xf
    v_add_f32_dpp v22, v23, v22 row_ror:12 row_mask:0xf bank_mask:0xf
    s_waitcnt vmcnt(41)
    v_mfma_f32_16x16x32_bf16 v[32:35], a[124:127], v[8:11], 0
    buffer_load_dwordx4 a[124:127], v2, s[24:27], 0 offen nt
    v_xor_b32 v2, s63, v2
    v_add_f32_dpp v71, v22, v20 row_ror:8 row_mask:0xf bank_mask:0x1
    v_add_f32_dpp v25, v26, v25 row_ror:12 row_mask:0xf bank_mask:0xf
    v_add_f32_dpp v27, v24, v27 row_ror:12 row_mask:0xf bank_mask:0xf
    s_waitcnt vmcnt(41)
    v_mfma_f32_16x16x32_bf16 v[20:23], a[128:131], v[8:11], 0
    buffer_load_dwordx4 a[128:131], v2, s[24:27], 0 offen nt
    v_xor_b32 v2, s62, v2
    v_add_f32_dpp v71, v27, v25 row_ror:8 row_mask:0xf bank_mask:0x2
    v_add_f32_dpp v30, v31, v30 row_ror:12 row_mask:0xf bank_mask:0xf
    v_add_f32_dpp v28, v29, v28 row_ror:12 row_mask:0xf bank_mask:0xf
    s_waitcnt vmcnt(41)
    v_mfma_f32_16x16x32_bf16 v[24:27], a[132:135], v[8:11], 0
    buffer_load_dwordx4 a[132:135], v2, s[24:27], 0 offen nt
    v_xor_b32 v2, s64, v2
    v_add_f32_dpp v71, v28, v30 row_ror:8 row_mask:0xf bank_mask:0x4
    v_add_f32_dpp v35, v32, v35 row_ror:12 row_mask:0xf bank_mask:0xf
    v_add_f32_dpp v33, v34, v33 row_ror:12 row_mask:0xf bank_mask:0xf
    s_waitcnt vmcnt(41)
    v_mfma_f32_16x16x32_bf16 v[28:31], a[136:139], v[8:11], 0
    buffer_load_dwordx4 a[136:139], v2, s[24:27], 0 offen nt
    v_xor_b32 v2, s62, v2
    v_add_f32_dpp v71, v33, v35 row_ror:8 row_mask:0xf bank_mask:0x8
    v_add_f32_dpp v20, v21, v20 row_ror:12 row_mask:0xf bank_mask:0xf
    v_add_f32_dpp v22, v23, v22 row_ror:12 row_mask:0xf bank_mask:0xf
    s_waitcnt vmcnt(41)
    v_mfma_f32_16x16x32_bf16 v[32:35], a[140:143], v[8:11], 0
    buffer_load_dwordx4 a[140:143], v2, s[24:27], 0 offen nt
    v_xor_b32 v2, s63, v2
    v_add_f32_dpp v72, v22, v20 row_ror:8 row_mask:0xf bank_mask:0x1
    v_add_f32_dpp v25, v26, v25 row_ror:12 row_mask:0xf bank_mask:0xf
    v_add_f32_dpp v27, v24, v27 row_ror:12 row_mask:0xf bank_mask:0xf
    s_waitcnt vmcnt(41)
    v_mfma_f32_16x16x32_bf16 v[20:23], a[144:147], v[8:11], 0
    buffer_load_dwordx4 a[144:147], v2, s[24:27], 0 offen nt
    v_xor_b32 v2, s62, v2
    v_add_f32_dpp v72, v27, v25 row_ror:8 row_mask:0xf bank_mask:0x2
    v_max3_f32 v97, v97, v70, v71
    v_add_f32_dpp v30, v31, v30 row_ror:12 row_mask:0xf bank_mask:0xf
    v_add_f32_dpp v28, v29, v28 row_ror:12 row_mask:0xf bank_mask:0xf
    s_waitcnt vmcnt(41)
    v_mfma_f32_16x16x32_bf16 v[24:27], a[148:151], v[8:11], 0
    buffer_load_dwordx4 a[148:151], v2, s[24:27], 0 offen nt
    v_xor_b32 v2, s66, v2
    v_add_f32_dpp v72, v28, v30 row_ror:8 row_mask:0xf bank_mask:0x4
    v_add_f32_dpp v35, v32, v35 row_ror:12 row_mask:0xf bank_mask:0xf
    v_add_f32_dpp v33, v34, v33 row_ror:12 row_mask:0xf bank_mask:0xf
    s_waitcnt vmcnt(41)
    v_mfma_f32_16x16x32_bf16 v[28:31], a[152:155], v[8:11], 0
    buffer_load_dwordx4 a[152:155], v2, s[24:27], 0 offen nt
    v_xor_b32 v2, s62, v2
    v_add_f32_dpp v72, v33, v35 row_ror:8 row_mask:0xf bank_mask:0x8
    v_add_f32_dpp v20, v21, v20 row_ror:12 row_mask:0xf bank_mask:0xf
    v_add_f32_dpp v22, v23, v22 row_ror:12 row_mask:0xf bank_mask:0xf
    s_waitcnt vmcnt(41)
    v_mfma_f32_16x16x32_bf16 v[32:35], a[156:159], v[8:11], 0
    buffer_load_dwordx4 a[156:159], v2, s[24:27], 0 offen nt
    v_xor_b32 v2, s63, v2
    v_add_f32_dpp v73, v22, v20 row_ror:8 row_mask:0xf bank_mask:0x1
    v_add_f32_dpp v25, v26, v25 row_ror:12 row_mask:0xf bank_mask:0xf
    v_add_f32_dpp v27, v24, v27 row_ror:12 row_mask:0xf bank_mask:0xf
    s_waitcnt vmcnt(41)
    v_mfma_f32_16x16x32_bf16 v[20:23], a[160:163], v[8:11], 0
    buffer_load_dwordx4 a[160:163], v2, s[24:27], 0 offen nt
    v_xor_b32 v2, s62, v2
    v_add_f32_dpp v73, v27, v25 row_ror:8 row_mask:0xf bank_mask:0x2
    v_add_f32_dpp v30, v31, v30 row_ror:12 row_mask:0xf bank_mask:0xf
    v_add_f32_dpp v28, v29, v28 row_ror:12 row_mask:0xf bank_mask:0xf
    s_waitcnt vmcnt(41)
    v_mfma_f32_16x16x32_bf16 v[24:27], a[164:167], v[8:11], 0
    buffer_load_dwordx4 a[164:167], v2, s[24:27], 0 offen nt
    v_xor_b32 v2, s64, v2
    v_add_f32_dpp v73, v28, v30 row_ror:8 row_mask:0xf bank_mask:0x4
    v_add_f32_dpp v35, v32, v35 row_ror:12 row_mask:0xf bank_mask:0xf
    v_add_f32_dpp v33, v34, v33 row_ror:12 row_mask:0xf bank_mask:0xf
    s_waitcnt vmcnt(41)
    v_mfma_f32_16x16x32_bf16 v[28:31], a[0:3], v[8:11], 0
    buffer_load_dwordx4 a[0:3], v2, s[24:27], 0 offen nt
    v_xor_b32 v2, s62, v2
    v_add_f32_dpp v73, v33, v35 row_ror:8 row_mask:0xf bank_mask:0x8
    v_add_f32_dpp v20, v21, v20 row_ror:12 row_mask:0xf bank_mask:0xf
    v_add_f32_dpp v22, v23, v22 row_ror:12 row_mask:0xf bank_mask:0xf
    s_waitcnt vmcnt(41)
    v_mfma_f32_16x16x32_bf16 v[32:35], a[4:7], v[8:11], 0
    buffer_load_dwordx4 a[4:7], v2, s[24:27], 0 offen nt
    v_xor_b32 v2, s63, v2
    v_add_f32_dpp v74, v22, v20 row_ror:8 row_mask:0xf bank_mask:0x1
    v_add_f32_dpp v25, v26, v25 row_ror:12 row_mask:0xf bank_mask:0xf
    v_add_f32_dpp v27, v24, v27 row_ror:12 row_mask:0xf bank_mask:0xf
    s_waitcnt vmcnt(41)
    v_mfma_f32_16x16x32_bf16 v[20:23], a[8:11], v[8:11], 0
    buffer_load_dwordx4 a[8:11], v2, s[24:27], 0 offen nt
    v_xor_b32 v2, s62, v2
    v_add_f32_dpp v74, v27, v25 row_ror:8 row_mask:0xf bank_mask:0x2
    v_max3_f32 v97, v97, v72, v73
    v_add_f32_dpp v30, v31, v30 row_ror:12 row_mask:0xf bank_mask:0xf
    v_add_f32_dpp v28, v29, v28 row_ror:12 row_mask:0xf bank_mask:0xf
    s_waitcnt vmcnt(41)
    v_mfma_f32_16x16x32_bf16 v[24:27], a[12:15], v[8:11], 0
    buffer_load_dwordx4 a[12:15], v2, s[24:27], 0 offen nt
    v_xor_b32 v2, s65, v2
    v_add_f32_dpp v74, v28, v30 row_ror:8 row_mask:0xf bank_mask:0x4
    v_add_f32_dpp v35, v32, v35 row_ror:12 row_mask:0xf bank_mask:0xf
    v_add_f32_dpp v33, v34, v33 row_ror:12 row_mask:0xf bank_mask:0xf
    s_waitcnt vmcnt(41)
    v_mfma_f32_16x16x32_bf16 v[28:31], a[16:19], v[8:11], 0
    buffer_load_dwordx4 a[16:19], v2, s[24:27], 0 offen nt
    v_xor_b32 v2, s62, v2
    v_add_f32_dpp v74, v33, v35 row_ror:8 row_mask:0xf bank_mask:0x8
    v_add_f32_dpp v20, v21, v20 row_ror:12 row_mask:0xf bank_mask:0xf
    v_add_f32_dpp v22, v23, v22 row_ror:12 row_mask:0xf bank_mask:0xf
    s_waitcnt vmcnt(41)
    v_mfma_f32_16x16x32_bf16 v[32:35], a[20:23], v[8:11], 0
    buffer_load_dwordx4 a[20:23], v2, s[24:27], 0 offen nt
    v_xor_b32 v2, s63, v2
    v_add_f32_dpp v75, v22, v20 row_ror:8 row_mask:0xf bank_mask:0x1
    v_add_f32_dpp v25, v26, v25 row_ror:12 row_mask:0xf bank_mask:0xf
    v_add_f32_dpp v27, v24, v27 row_ror:12 row_mask:0xf bank_mask:0xf
    s_waitcnt vmcnt(41)
    v_mfma_f32_16x16x32_bf16 v[20:23], a[24:27], v[8:11], 0
    buffer_load_dwordx4 a[24:27], v2, s[24:27], 0 offen nt
    v_xor_b32 v2, s62, v2
    v_add_f32_dpp v75, v27, v25 row_ror:8 row_mask:0xf bank_mask:0x2
    v_add_f32_dpp v30, v31, v30 row_ror:12 row_mask:0xf bank_mask:0xf
    v_add_f32_dpp v28, v29, v28 row_ror:12 row_mask:0xf bank_mask:0xf
    s_waitcnt vmcnt(41)
    v_mfma_f32_16x16x32_bf16 v[24:27], a[28:31], v[8:11], 0
    buffer_load_dwordx4 a[28:31], v2, s[24:27], 0 offen nt
    v_xor_b32 v2, s64, v2
    v_add_f32_dpp v75, v28, v30 row_ror:8 row_mask:0xf bank_mask:0x4
    v_add_f32_dpp v35, v32, v35 row_ror:12 row_mask:0xf bank_mask:0xf
    v_add_f32_dpp v33, v34, v33 row_ror:12 row_mask:0xf bank_mask:0xf
    s_waitcnt vmcnt(41)
    v_mfma_f32_16x16x32_bf16 v[28:31], a[32:35], v[8:11], 0
    buffer_load_dwordx4 a[32:35], v2, s[24:27], 0 offen nt
    v_xor_b32 v2, s62, v2
    v_add_f32_dpp v75, v33, v35 row_ror:8 row_mask:0xf bank_mask:0x8
    v_add_f32_dpp v20, v21, v20 row_ror:12 row_mask:0xf bank_mask:0xf
    v_add_f32_dpp v22, v23, v22 row_ror:12 row_mask:0xf bank_mask:0xf
    s_waitcnt vmcnt(41)
    v_mfma_f32_16x16x32_bf16 v[32:35], a[36:39], v[8:11], 0
    buffer_load_dwordx4 a[36:39], v2, s[24:27], 0 offen nt
    v_xor_b32 v2, s63, v2
    v_add_f32_dpp v76, v22, v20 row_ror:8 row_mask:0xf bank_mask:0x1
    v_add_f32_dpp v25, v26, v25 row_ror:12 row_mask:0xf bank_mask:0xf
    v_add_f32_dpp v27, v24, v27 row_ror:12 row_mask:0xf bank_mask:0xf
    s_waitcnt vmcnt(41)
    v_mfma_f32_16x16x32_bf16 v[20:23], a[40:43], v[8:11], 0
    buffer_load_dwordx4 a[40:43], v2, s[24:27], 0 offen nt
    v_xor_b32 v2, s62, v2
    v_add_f32_dpp v76, v27, v25 row_ror:8 row_mask:0xf bank_mask:0x2
    v_max3_f32 v97, v97, v74, v75
    v_add_f32_dpp v30, v31, v30 row_ror:12 row_mask:0xf bank_mask:0xf
    v_add_f32_dpp v28, v29, v28 row_ror:12 row_mask:0xf bank_mask:0xf
    s_waitcnt vmcnt(41)
    v_mfma_f32_16x16x32_bf16 v[24:27], a[44:47], v[8:11], 0
    buffer_load_dwordx4 a[44:47], v2, s[24:27], 0 offen nt
    v_xor_b32 v2, s67, v2
    v_add_f32_dpp v76, v28, v30 row_ror:8 row_mask:0xf bank_mask:0x4
    v_add_f32_dpp v35, v32, v35 row_ror:12 row_mask:0xf bank_mask:0xf
    v_add_f32_dpp v33, v34, v33 row_ror:12 row_mask:0xf bank_mask:0xf
    s_waitcnt vmcnt(41)
    v_mfma_f32_16x16x32_bf16 v[28:31], a[48:51], v[8:11], 0
    buffer_load_dwordx4 a[48:51], v2, s[24:27], 0 offen nt
    v_xor_b32 v2, s62, v2
    v_add_f32_dpp v76, v33, v35 row_ror:8 row_mask:0xf bank_mask:0x8
    v_add_f32_dpp v20, v21, v20 row_ror:12 row_mask:0xf bank_mask:0xf
    v_add_f32_dpp v22, v23, v22 row_ror:12 row_mask:0xf bank_mask:0xf
    s_waitcnt vmcnt(41)
    v_mfma_f32_16x16x32_bf16 v[32:35], a[52:55], v[8:11], 0
    buffer_load_dwordx4 a[52:55], v2, s[24:27], 0 offen nt
    v_xor_b32 v2, s63, v2
    v_add_f32_dpp v77, v22, v20 row_ror:8 row_mask:0xf bank_mask:0x1
    v_add_f32_dpp v25, v26, v25 row_ror:12 row_mask:0xf bank_mask:0xf
    v_add_f32_dpp v27, v24, v27 row_ror:12 row_mask:0xf bank_mask:0xf
    s_waitcnt vmcnt(41)
    v_mfma_f32_16x16x32_bf16 v[20:23], a[56:59], v[8:11], 0
    buffer_load_dwordx4 a[56:59], v2, s[24:27], 0 offen nt
    v_xor_b32 v2, s62, v2
    v_add_f32_dpp v77, v27, v25 row_ror:8 row_mask:0xf bank_mask:0x2
    v_add_f32_dpp v30, v31, v30 row_ror:12 row_mask:0xf bank_mask:0xf
    v_add_f32_dpp v28, v29, v28 row_ror:12 row_mask:0xf bank_mask:0xf
    s_waitcnt vmcnt(41)
    v_mfma_f32_16x16x32_bf16 v[24:27], a[60:63], v[8:11], 0
    buffer_load_dwordx4 a[60:63], v2, s[24:27], 0 offen nt
    v_xor_b32 v2, s64, v2
    v_add_f32_dpp v77, v28, v30 row_ror:8 row_mask:0xf bank_mask:0x4
    v_add_f32_dpp v35, v32, v35 row_ror:12 row_mask:0xf bank_mask:0xf
    v_add_f32_dpp v33, v34, v33 row_ror:12 row_mask:0xf bank_mask:0xf
    s_waitcnt vmcnt(41)
    v_mfma_f32_16x16x32_bf16 v[28:31], a[64:67], v[8:11], 0
    buffer_load_dwordx4 a[64:67], v2, s[24:27], 0 offen nt
    v_xor_b32 v2, s62, v2
    v_add_f32_dpp v77, v33, v35 row_ror:8 row_mask:0xf bank_mask:0x8
    v_add_f32_dpp v20, v21, v20 row_ror:12 row_mask:0xf bank_mask:0xf
    v_add_f32_dpp v22, v23, v22 row_ror:12 row_mask:0xf bank_mask:0xf
    s_waitcnt vmcnt(41)
    v_mfma_f32_16x16x32_bf16 v[32:35], a[68:71], v[8:11], 0
    buffer_load_dwordx4 a[68:71], v2, s[24:27], 0 offen nt
    v_xor_b32 v2, s63, v2
    v_add_f32_dpp v78, v22, v20 row_ror:8 row_mask:0xf bank_mask:0x1
    v_add_f32_dpp v25, v26, v25 row_ror:12 row_mask:0xf bank_mask:0xf
    v_add_f32_dpp v27, v24, v27 row_ror:12 row_mask:0xf bank_mask:0xf
    s_waitcnt vmcnt(41)
    v_mfma_f32_16x16x32_bf16 v[20:23], a[72:75], v[8:11], 0
    buffer_load_dwordx4 a[72:75], v2, s[24:27], 0 offen nt
    v_xor_b32 v2, s62, v2
    v_add_f32_dpp v78, v27, v25 row_ror:8 row_mask:0xf bank_mask:0x2
    v_max3_f32 v97, v97, v76, v77
    v_add_f32_dpp v30, v31, v30 row_ror:12 row_mask:0xf bank_mask:0xf
    v_add_f32_dpp v28, v29, v28 row_ror:12 row_mask:0xf bank_mask:0xf
    s_waitcnt vmcnt(41)
    v_mfma_f32_16x16x32_bf16 v[24:27], a[76:79], v[8:11], 0
    buffer_load_dwordx4 a[76:79], v2, s[24:27], 0 offen nt
    v_xor_b32 v2, s65, v2
    v_add_f32_dpp v78, v28, v30 row_ror:8 row_mask:0xf bank_mask:0x4
    v_add_f32_dpp v35, v32, v35 row_ror:12 row_mask:0xf bank_mask:0xf
    v_add_f32_dpp v33, v34, v33 row_ror:12 row_mask:0xf bank_mask:0xf
    s_waitcnt vmcnt(41)
    v_mfma_f32_16x16x32_bf16 v[28:31], a[80:83], v[8:11], 0
    buffer_load_dwordx4 a[80:83], v2, s[24:27], 0 offen nt
    v_xor_b32 v2, s62, v2
    v_add_f32_dpp v78, v33, v35 row_ror:8 row_mask:0xf bank_mask:0x8
    v_add_f32_dpp v20, v21, v20 row_ror:12 row_mask:0xf bank_mask:0xf
    v_add_f32_dpp v22, v23, v22 row_ror:12 row_mask:0xf bank_mask:0xf
    s_waitcnt vmcnt(41)
    v_mfma_f32_16x16x32_bf16 v[32:35], a[84:87], v[8:11], 0
    buffer_load_dwordx4 a[84:87], v2, s[24:27], 0 offen nt
    v_xor_b32 v2, s63, v2
    v_add_f32_dpp v79, v22, v20 row_ror:8 row_mask:0xf bank_mask:0x1
    v_add_f32_dpp v25, v26, v25 row_ror:12 row_mask:0xf bank_mask:0xf
    v_add_f32_dpp v27, v24, v27 row_ror:12 row_mask:0xf bank_mask:0xf
    s_waitcnt vmcnt(41)
    v_mfma_f32_16x16x32_bf16 v[20:23], a[88:91], v[8:11], 0
    buffer_load_dwordx4 a[88:91], v2, s[24:27], 0 offen nt
    v_xor_b32 v2, s62, v2
    v_add_f32_dpp v79, v27, v25 row_ror:8 row_mask:0xf bank_mask:0x2
    v_add_f32_dpp v30, v31, v30 row_ror:12 row_mask:0xf bank_mask:0xf
    v_add_f32_dpp v28, v29, v28 row_ror:12 row_mask:0xf bank_mask:0xf
    s_waitcnt vmcnt(41)
    v_mfma_f32_16x16x32_bf16 v[24:27], a[92:95], v[8:11], 0
    buffer_load_dwordx4 a[92:95], v2, s[24:27], 0 offen nt
    v_xor_b32 v2, s64, v2
    v_add_f32_dpp v79, v28, v30 row_ror:8 row_mask:0xf bank_mask:0x4
    v_add_f32_dpp v35, v32, v35 row_ror:12 row_mask:0xf bank_mask:0xf
    v_add_f32_dpp v33, v34, v33 row_ror:12 row_mask:0xf bank_mask:0xf
    s_waitcnt vmcnt(41)
    v_mfma_f32_16x16x32_bf16 v[28:31], a[96:99], v[8:11], 0
    buffer_load_dwordx4 a[96:99], v2, s[24:27], 0 offen nt
    v_xor_b32 v2, s62, v2
    v_add_f32_dpp v79, v33, v35 row_ror:8 row_mask:0xf bank_mask:0x8
    v_add_f32_dpp v20, v21, v20 row_ror:12 row_mask:0xf bank_mask:0xf
    v_add_f32_dpp v22, v23, v22 row_ror:12 row_mask:0xf bank_mask:0xf
    s_waitcnt vmcnt(41)
    v_mfma_f32_16x16x32_bf16 v[32:35], a[100:103], v[8:11], 0
    buffer_load_dwordx4 a[100:103], v2, s[24:27], 0 offen nt
    v_xor_b32 v2, s63, v2
    v_add_f32_dpp v80, v22, v20 row_ror:8 row_mask:0xf bank_mask:0x1
    v_add_f32_dpp v25, v26, v25 row_ror:12 row_mask:0xf bank_mask:0xf
    v_add_f32_dpp v27, v24, v27 row_ror:12 row_mask:0xf bank_mask:0xf
    s_waitcnt vmcnt(41)
    v_mfma_f32_16x16x32_bf16 v[20:23], a[104:107], v[8:11], 0
    buffer_load_dwordx4 a[104:107], v2, s[24:27], 0 offen nt
    v_xor_b32 v2, s62, v2
    v_add_f32_dpp v80, v27, v25 row_ror:8 row_mask:0xf bank_mask:0x2
    v_max3_f32 v97, v97, v78, v79
    v_add_f32_dpp v30, v31, v30 row_ror:12 row_mask:0xf bank_mask:0xf
    v_add_f32_dpp v28, v29, v28 row_ror:12 row_mask:0xf bank_mask:0xf
    s_waitcnt vmcnt(41)
    v_mfma_f32_16x16x32_bf16 v[24:27], a[108:111], v[8:11], 0
    buffer_load_dwordx4 a[108:111], v2, s[24:27], 0 offen nt
    v_xor_b32 v2, s66, v2
    v_add_f32_dpp v80, v28, v30 row_ror:8 row_mask:0xf bank_mask:0x4
    v_add_f32_dpp v35, v32, v35 row_ror:12 row_mask:0xf bank_mask:0xf
    v_add_f32_dpp v33, v34, v33 row_ror:12 row_mask:0xf bank_mask:0xf
    s_waitcnt vmcnt(41)
    v_mfma_f32_16x16x32_bf16 v[28:31], a[112:115], v[8:11], 0
    buffer_load_dwordx4 a[112:115], v2, s[24:27], 0 offen nt
    v_xor_b32 v2, s62, v2
    v_add_f32_dpp v80, v33, v35 row_ror:8 row_mask:0xf bank_mask:0x8
    v_add_f32_dpp v20, v21, v20 row_ror:12 row_mask:0xf bank_mask:0xf
    v_add_f32_dpp v22, v23, v22 row_ror:12 row_mask:0xf bank_mask:0xf
    s_waitcnt vmcnt(41)
    v_mfma_f32_16x16x32_bf16 v[32:35], a[116:119], v[8:11], 0
    buffer_load_dwordx4 a[116:119], v2, s[24:27], 0 offen nt
    v_xor_b32 v2, s63, v2
    v_add_f32_dpp v81, v22, v20 row_ror:8 row_mask:0xf bank_mask:0x1
    v_add_f32_dpp v25, v26, v25 row_ror:12 row_mask:0xf bank_mask:0xf
    v_add_f32_dpp v27, v24, v27 row_ror:12 row_mask:0xf bank_mask:0xf
    s_waitcnt vmcnt(41)
    v_mfma_f32_16x16x32_bf16 v[20:23], a[120:123], v[8:11], 0
    buffer_load_dwordx4 a[120:123], v2, s[24:27], 0 offen nt
    v_xor_b32 v2, s62, v2
    v_add_f32_dpp v81, v27, v25 row_ror:8 row_mask:0xf bank_mask:0x2
    v_add_f32_dpp v30, v31, v30 row_ror:12 row_mask:0xf bank_mask:0xf
    v_add_f32_dpp v28, v29, v28 row_ror:12 row_mask:0xf bank_mask:0xf
    s_waitcnt vmcnt(41)
    v_mfma_f32_16x16x32_bf16 v[24:27], a[124:127], v[8:11], 0
    buffer_load_dwordx4 a[124:127], v2, s[24:27], 0 offen nt
    v_xor_b32 v2, s64, v2
    v_add_f32_dpp v81, v28, v30 row_ror:8 row_mask:0xf bank_mask:0x4
    v_add_f32_dpp v35, v32, v35 row_ror:12 row_mask:0xf bank_mask:0xf
    v_add_f32_dpp v33, v34, v33 row_ror:12 row_mask:0xf bank_mask:0xf
    s_waitcnt vmcnt(41)
    v_mfma_f32_16x16x32_bf16 v[28:31], a[128:131], v[8:11], 0
    buffer_load_dwordx4 a[128:131], v2, s[24:27], 0 offen nt
    v_xor_b32 v2, s62, v2
    v_add_f32_dpp v81, v33, v35 row_ror:8 row_mask:0xf bank_mask:0x8
    v_add_f32_dpp v20, v21, v20 row_ror:12 row_mask:0xf bank_mask:0xf
    v_add_f32_dpp v22, v23, v22 row_ror:12 row_mask:0xf bank_mask:0xf
    s_waitcnt vmcnt(41)
    v_mfma_f32_16x16x32_bf16 v[32:35], a[132:135], v[8:11], 0
    buffer_load_dwordx4 a[132:135], v2, s[24:27], 0 offen nt
    v_xor_b32 v2, s63, v2
    v_add_f32_dpp v82, v22, v20 row_ror:8 row_mask:0xf bank_mask:0x1
    v_add_f32_dpp v25, v26, v25 row_ror:12 row_mask:0xf bank_mask:0xf
    v_add_f32_dpp v27, v24, v27 row_ror:12 row_mask:0xf bank_mask:0xf
    s_waitcnt vmcnt(41)
    v_mfma_f32_16x16x32_bf16 v[20:23], a[136:139], v[8:11], 0
    buffer_load_dwordx4 a[136:139], v2, s[24:27], 0 offen nt
    v_xor_b32 v2, s62, v2
    v_add_f32_dpp v82, v27, v25 row_ror:8 row_mask:0xf bank_mask:0x2
    v_max3_f32 v97, v97, v80, v81
    v_add_f32_dpp v30, v31, v30 row_ror:12 row_mask:0xf bank_mask:0xf
    v_add_f32_dpp v28, v29, v28 row_ror:12 row_mask:0xf bank_mask:0xf
    s_waitcnt vmcnt(41)
    v_mfma_f32_16x16x32_bf16 v[24:27], a[140:143], v[8:11], 0
    buffer_load_dwordx4 a[140:143], v2, s[24:27], 0 offen nt
    v_xor_b32 v2, s65, v2
    v_add_f32_dpp v82, v28, v30 row_ror:8 row_mask:0xf bank_mask:0x4
    v_add_f32_dpp v35, v32, v35 row_ror:12 row_mask:0xf bank_mask:0xf
    v_add_f32_dpp v33, v34, v33 row_ror:12 row_mask:0xf bank_mask:0xf
    s_waitcnt vmcnt(41)
    v_mfma_f32_16x16x32_bf16 v[28:31], a[144:147], v[8:11], 0
    buffer_load_dwordx4 a[144:147], v2, s[24:27], 0 offen nt
    v_xor_b32 v2, s62, v2
    v_add_f32_dpp v82, v33, v35 row_ror:8 row_mask:0xf bank_mask:0x8
    v_add_f32_dpp v20, v21, v20 row_ror:12 row_mask:0xf bank_mask:0xf
    v_add_f32_dpp v22, v23, v22 row_ror:12 row_mask:0xf bank_mask:0xf
    s_waitcnt vmcnt(41)
    v_mfma_f32_16x16x32_bf16 v[32:35], a[148:151], v[8:11], 0
    buffer_load_dwordx4 a[148:151], v2, s[24:27], 0 offen nt
    v_xor_b32 v2, s63, v2
    v_add_f32_dpp v83, v22, v20 row_ror:8 row_mask:0xf bank_mask:0x1
    v_add_f32_dpp v25, v26, v25 row_ror:12 row_mask:0xf bank_mask:0xf
    v_add_f32_dpp v27, v24, v27 row_ror:12 row_mask:0xf bank_mask:0xf
    s_waitcnt vmcnt(41)
    v_mfma_f32_16x16x32_bf16 v[20:23], a[152:155], v[8:11], 0
    buffer_load_dwordx4 a[152:155], v2, s[24:27], 0 offen nt
    v_xor_b32 v2, s62, v2
    v_add_f32_dpp v83, v27, v25 row_ror:8 row_mask:0xf bank_mask:0x2
    v_add_f32_dpp v30, v31, v30 row_ror:12 row_mask:0xf bank_mask:0xf
    v_add_f32_dpp v28, v29, v28 row_ror:12 row_mask:0xf bank_mask:0xf
    s_waitcnt vmcnt(41)
    v_mfma_f32_16x16x32_bf16 v[24:27], a[156:159], v[8:11], 0
    buffer_load_dwordx4 a[156:159], v2, s[24:27], 0 offen nt
    v_xor_b32 v2, s64, v2
    v_add_f32_dpp v83, v28, v30 row_ror:8 row_mask:0xf bank_mask:0x4
    v_add_f32_dpp v35, v32, v35 row_ror:12 row_mask:0xf bank_mask:0xf
    v_add_f32_dpp v33, v34, v33 row_ror:12 row_mask:0xf bank_mask:0xf
    s_waitcnt vmcnt(41)
    v_mfma_f32_16x16x32_bf16 v[28:31], a[160:163], v[8:11], 0
    buffer_load_dwordx4 a[160:163], v2, s[24:27], 0 offen nt
    v_xor_b32 v2, s62, v2
    v_add_f32_dpp v83, v33, v35 row_ror:8 row_mask:0xf bank_mask:0x8
    v_add_f32_dpp v20, v21, v20 row_ror:12 row_mask:0xf bank_mask:0xf
    v_add_f32_dpp v22, v23, v22 row_ror:12 row_mask:0xf bank_mask:0xf
    s_waitcnt vmcnt(41)
    v_mfma_f32_16x16x32_bf16 v[32:35], a[164:167], v[8:11], 0
    buffer_load_dwordx4 a[164:167], v2, s[24:27], 0 offen nt
    v_xor_b32 v2, s63, v2
    v_add_f32_dpp v84, v22, v20 row_ror:8 row_mask:0xf bank_mask:0x1
    v_add_f32_dpp v25, v26, v25 row_ror:12 row_mask:0xf bank_mask:0xf
    v_add_f32_dpp v27, v24, v27 row_ror:12 row_mask:0xf bank_mask:0xf
    s_waitcnt vmcnt(41)
    v_mfma_f32_16x16x32_bf16 v[20:23], a[0:3], v[8:11], 0
    buffer_load_dwordx4 a[0:3], v2, s[24:27], 0 offen nt
    v_xor_b32 v2, s62, v2
    v_add_f32_dpp v84, v27, v25 row_ror:8 row_mask:0xf bank_mask:0x2
    v_max3_f32 v97, v97, v82, v83
    v_add_f32_dpp v30, v31, v30 row_ror:12 row_mask:0xf bank_mask:0xf
    v_add_f32_dpp v28, v29, v28 row_ror:12 row_mask:0xf bank_mask:0xf
    s_waitcnt vmcnt(41)
    v_mfma_f32_16x16x32_bf16 v[24:27], a[4:7], v[8:11], 0
    buffer_load_dwordx4 a[4:7], v2, s[24:27], 0 offen nt
    v_add_f32_dpp v84, v28, v30 row_ror:8 row_mask:0xf bank_mask:0x4
    v_add_f32_dpp v35, v32, v35 row_ror:12 row_mask:0xf bank_mask:0xf
    v_add_f32_dpp v33, v34, v33 row_ror:12 row_mask:0xf bank_mask:0xf
    s_waitcnt vmcnt(41)
    v_mfma_f32_16x16x32_bf16 v[28:31], a[8:11], v[8:11], 0
    v_add_f32_dpp v84, v33, v35 row_ror:8 row_mask:0xf bank_mask:0x8
    v_add_f32_dpp v20, v21, v20 row_ror:12 row_mask:0xf bank_mask:0xf
    v_add_f32_dpp v22, v23, v22 row_ror:12 row_mask:0xf bank_mask:0xf
    s_waitcnt vmcnt(40)
    v_mfma_f32_16x16x32_bf16 v[32:35], a[12:15], v[8:11], 0
    v_add_f32_dpp v85, v22, v20 row_ror:8 row_mask:0xf bank_mask:0x1
    v_add_f32_dpp v25, v26, v25 row_ror:12 row_mask:0xf bank_mask:0xf
    v_add_f32_dpp v27, v24, v27 row_ror:12 row_mask:0xf bank_mask:0xf
    s_waitcnt vmcnt(39)
    v_mfma_f32_16x16x32_bf16 v[20:23], a[16:19], v[8:11], 0
    v_add_f32_dpp v85, v27, v25 row_ror:8 row_mask:0xf bank_mask:0x2
    v_add_f32_dpp v30, v31, v30 row_ror:12 row_mask:0xf bank_mask:0xf
    v_add_f32_dpp v28, v29, v28 row_ror:12 row_mask:0xf bank_mask:0xf
    s_waitcnt vmcnt(38)
    v_mfma_f32_16x16x32_bf16 v[24:27], a[20:23], v[8:11], 0
    v_add_f32_dpp v85, v28, v30 row_ror:8 row_mask:0xf bank_mask:0x4
    v_add_f32_dpp v35, v32, v35 row_ror:12 row_mask:0xf bank_mask:0xf
    v_add_f32_dpp v33, v34, v33 row_ror:12 row_mask:0xf bank_mask:0xf
    s_waitcnt vmcnt(37)
    v_mfma_f32_16x16x32_bf16 v[28:31], a[24:27], v[8:11], 0
    v_add_f32_dpp v85, v33, v35 row_ror:8 row_mask:0xf bank_mask:0x8
    v_add_f32_dpp v20, v21, v20 row_ror:12 row_mask:0xf bank_mask:0xf
    v_add_f32_dpp v22, v23, v22 row_ror:12 row_mask:0xf bank_mask:0xf
    s_waitcnt vmcnt(36)
    v_mfma_f32_16x16x32_bf16 v[32:35], a[28:31], v[8:11], 0
    v_add_f32_dpp v86, v22, v20 row_ror:8 row_mask:0xf bank_mask:0x1
    v_add_f32_dpp v25, v26, v25 row_ror:12 row_mask:0xf bank_mask:0xf
    v_add_f32_dpp v27, v24, v27 row_ror:12 row_mask:0xf bank_mask:0xf
    s_waitcnt vmcnt(35)
    v_mfma_f32_16x16x32_bf16 v[20:23], a[32:35], v[8:11], 0
    s_load_dword s17, s[52:53], s18
    v_add_f32_dpp v86, v27, v25 row_ror:8 row_mask:0xf bank_mask:0x2
    v_max3_f32 v97, v97, v84, v85
    v_add_f32_dpp v30, v31, v30 row_ror:12 row_mask:0xf bank_mask:0xf
    v_add_f32_dpp v28, v29, v28 row_ror:12 row_mask:0xf bank_mask:0xf
    s_waitcnt vmcnt(34)
    v_mfma_f32_16x16x32_bf16 v[24:27], a[36:39], v[8:11], 0
    v_add_f32_dpp v86, v28, v30 row_ror:8 row_mask:0xf bank_mask:0x4
    v_add_f32_dpp v35, v32, v35 row_ror:12 row_mask:0xf bank_mask:0xf
    v_add_f32_dpp v33, v34, v33 row_ror:12 row_mask:0xf bank_mask:0xf
    s_waitcnt vmcnt(33)
    v_mfma_f32_16x16x32_bf16 v[28:31], a[40:43], v[8:11], 0
    v_add_f32_dpp v86, v33, v35 row_ror:8 row_mask:0xf bank_mask:0x8
    v_add_f32_dpp v20, v21, v20 row_ror:12 row_mask:0xf bank_mask:0xf
    v_add_f32_dpp v22, v23, v22 row_ror:12 row_mask:0xf bank_mask:0xf
    s_waitcnt vmcnt(32)
    v_mfma_f32_16x16x32_bf16 v[32:35], a[44:47], v[8:11], 0
    v_add_f32_dpp v87, v22, v20 row_ror:8 row_mask:0xf bank_mask:0x1
    v_add_f32_dpp v25, v26, v25 row_ror:12 row_mask:0xf bank_mask:0xf
    v_add_f32_dpp v27, v24, v27 row_ror:12 row_mask:0xf bank_mask:0xf
    s_waitcnt vmcnt(31)
    v_mfma_f32_16x16x32_bf16 v[20:23], a[48:51], v[8:11], 0
    v_add_f32_dpp v87, v27, v25 row_ror:8 row_mask:0xf bank_mask:0x2
    v_add_f32_dpp v30, v31, v30 row_ror:12 row_mask:0xf bank_mask:0xf
    v_add_f32_dpp v28, v29, v28 row_ror:12 row_mask:0xf bank_mask:0xf
    s_waitcnt vmcnt(30)
    v_mfma_f32_16x16x32_bf16 v[24:27], a[52:55], v[8:11], 0
    v_add_f32_dpp v87, v28, v30 row_ror:8 row_mask:0xf bank_mask:0x4
    v_add_f32_dpp v35, v32, v35 row_ror:12 row_mask:0xf bank_mask:0xf
    v_add_f32_dpp v33, v34, v33 row_ror:12 row_mask:0xf bank_mask:0xf
    s_waitcnt vmcnt(29)
    v_mfma_f32_16x16x32_bf16 v[28:31], a[56:59], v[8:11], 0
    v_add_f32_dpp v87, v33, v35 row_ror:8 row_mask:0xf bank_mask:0x8
    v_add_f32_dpp v20, v21, v20 row_ror:12 row_mask:0xf bank_mask:0xf
    v_add_f32_dpp v22, v23, v22 row_ror:12 row_mask:0xf bank_mask:0xf
    s_waitcnt vmcnt(28)
    v_mfma_f32_16x16x32_bf16 v[32:35], a[60:63], v[8:11], 0
    v_add_f32_dpp v88, v22, v20 row_ror:8 row_mask:0xf bank_mask:0x1
    v_add_f32_dpp v25, v26, v25 row_ror:12 row_mask:0xf bank_mask:0xf
    v_add_f32_dpp v27, v24, v27 row_ror:12 row_mask:0xf bank_mask:0xf
    s_waitcnt vmcnt(27)
    v_mfma_f32_16x16x32_bf16 v[20:23], a[64:67], v[8:11], 0
    v_add_f32_dpp v88, v27, v25 row_ror:8 row_mask:0xf bank_mask:0x2
    v_max3_f32 v97, v97, v86, v87
    v_add_f32_dpp v30, v31, v30 row_ror:12 row_mask:0xf bank_mask:0xf
    v_add_f32_dpp v28, v29, v28 row_ror:12 row_mask:0xf bank_mask:0xf
    s_waitcnt vmcnt(26)
    v_mfma_f32_16x16x32_bf16 v[24:27], a[68:71], v[8:11], 0
    v_add_f32_dpp v88, v28, v30 row_ror:8 row_mask:0xf bank_mask:0x4
    v_add_f32_dpp v35, v32, v35 row_ror:12 row_mask:0xf bank_mask:0xf
    v_add_f32_dpp v33, v34, v33 row_ror:12 row_mask:0xf bank_mask:0xf
    s_waitcnt vmcnt(25)
    v_mfma_f32_16x16x32_bf16 v[28:31], a[72:75], v[8:11], 0
    v_add_f32_dpp v88, v33, v35 row_ror:8 row_mask:0xf bank_mask:0x8
    v_add_f32_dpp v20, v21, v20 row_ror:12 row_mask:0xf bank_mask:0xf
    v_add_f32_dpp v22, v23, v22 row_ror:12 row_mask:0xf bank_mask:0xf
    s_waitcnt vmcnt(24)
    v_mfma_f32_16x16x32_bf16 v[32:35], a[76:79], v[8:11], 0
    v_add_f32_dpp v89, v22, v20 row_ror:8 row_mask:0xf bank_mask:0x1
    v_add_f32_dpp v25, v26, v25 row_ror:12 row_mask:0xf bank_mask:0xf
    v_add_f32_dpp v27, v24, v27 row_ror:12 row_mask:0xf bank_mask:0xf
    s_waitcnt vmcnt(23)
    v_mfma_f32_16x16x32_bf16 v[20:23], a[80:83], v[8:11], 0
    v_add_f32_dpp v89, v27, v25 row_ror:8 row_mask:0xf bank_mask:0x2
    v_add_f32_dpp v30, v31, v30 row_ror:12 row_mask:0xf bank_mask:0xf
    v_add_f32_dpp v28, v29, v28 row_ror:12 row_mask:0xf bank_mask:0xf
    s_waitcnt vmcnt(22)
    v_mfma_f32_16x16x32_bf16 v[24:27], a[84:87], v[8:11], 0
    v_add_f32_dpp v89, v28, v30 row_ror:8 row_mask:0xf bank_mask:0x4
    v_add_f32_dpp v35, v32, v35 row_ror:12 row_mask:0xf bank_mask:0xf
    v_add_f32_dpp v33, v34, v33 row_ror:12 row_mask:0xf bank_mask:0xf
    s_waitcnt vmcnt(21)
    v_mfma_f32_16x16x32_bf16 v[28:31], a[88:91], v[8:11], 0
    v_add_f32_dpp v89, v33, v35 row_ror:8 row_mask:0xf bank_mask:0x8
    v_add_f32_dpp v20, v21, v20 row_ror:12 row_mask:0xf bank_mask:0xf
    v_add_f32_dpp v22, v23, v22 row_ror:12 row_mask:0xf bank_mask:0xf
    s_waitcnt vmcnt(20)
    v_mfma_f32_16x16x32_bf16 v[32:35], a[92:95], v[8:11], 0
    buffer_load_dwordx4 a[8:11], v103, s[28:31], 0 offen nt
    v_xor_b32 v103, s62, v103
    buffer_load_dwordx4 a[12:15], v103, s[28:31], 0 offen nt
    v_xor_b32 v103, s63, v103
    buffer_load_dwordx4 a[16:19], v103, s[28:31], 0 offen nt
    v_xor_b32 v103, s62, v103
    buffer_load_dwordx4 a[20:23], v103, s[28:31], 0 offen nt
    v_xor_b32 v103, s64, v103
    buffer_load_dwordx4 a[24:27], v103, s[28:31], 0 offen nt
    v_xor_b32 v103, s62, v103
    buffer_load_dwordx4 a[28:31], v103, s[28:31], 0 offen nt
    v_xor_b32 v103, s63, v103
    buffer_load_dwordx4 a[32:35], v103, s[28:31], 0 offen nt
    v_xor_b32 v103, s62, v103
    buffer_load_dwordx4 a[36:39], v103, s[28:31], 0 offen nt
    v_xor_b32 v103, s65, v103
    buffer_load_dwordx4 a[40:43], v103, s[28:31], 0 offen nt
    v_xor_b32 v103, s62, v103
    buffer_load_dwordx4 a[44:47], v103, s[28:31], 0 offen nt
    v_xor_b32 v103, s63, v103
    buffer_load_dwordx4 a[48:51], v103, s[28:31], 0 offen nt
    v_xor_b32 v103, s62, v103
    buffer_load_dwordx4 a[52:55], v103, s[28:31], 0 offen nt
    v_xor_b32 v103, s64, v103
    buffer_load_dwordx4 a[56:59], v103, s[28:31], 0 offen nt
    v_xor_b32 v103, s62, v103
    buffer_load_dwordx4 a[60:63], v103, s[28:31], 0 offen nt
    v_xor_b32 v103, s63, v103
    buffer_load_dwordx4 a[64:67], v103, s[28:31], 0 offen nt
    v_xor_b32 v103, s62, v103
    buffer_load_dwordx4 a[68:71], v103, s[28:31], 0 offen nt
    v_xor_b32 v103, s66, v103
    buffer_load_dwordx4 a[72:75], v103, s[28:31], 0 offen nt
    v_xor_b32 v103, s62, v103
    buffer_load_dwordx4 a[76:79], v103, s[28:31], 0 offen nt
    v_xor_b32 v103, s63, v103
    buffer_load_dwordx4 a[80:83], v103, s[28:31], 0 offen nt
    v_xor_b32 v103, s62, v103
    buffer_load_dwordx4 a[84:87], v103, s[28:31], 0 offen nt
    v_xor_b32 v103, s64, v103
    buffer_load_dwordx4 a[88:91], v103, s[28:31], 0 offen nt
    v_xor_b32 v103, s62, v103
    buffer_load_dwordx4 a[92:95], v103, s[28:31], 0 offen nt
    v_xor_b32 v103, s63, v103
    v_add_f32_dpp v90, v22, v20 row_ror:8 row_mask:0xf bank_mask:0x1
    v_add_f32_dpp v25, v26, v25 row_ror:12 row_mask:0xf bank_mask:0xf
    v_add_f32_dpp v27, v24, v27 row_ror:12 row_mask:0xf bank_mask:0xf
    s_waitcnt vmcnt(41)
    v_mfma_f32_16x16x32_bf16 v[20:23], a[96:99], v[8:11], 0
    buffer_load_dwordx4 a[96:99], v103, s[28:31], 0 offen nt
    v_xor_b32 v103, s62, v103
    v_add_f32_dpp v90, v27, v25 row_ror:8 row_mask:0xf bank_mask:0x2
    v_max3_f32 v97, v97, v88, v89
    v_add_f32_dpp v30, v31, v30 row_ror:12 row_mask:0xf bank_mask:0xf
    v_add_f32_dpp v28, v29, v28 row_ror:12 row_mask:0xf bank_mask:0xf
    s_waitcnt vmcnt(41)
    v_mfma_f32_16x16x32_bf16 v[24:27], a[100:103], v[8:11], 0
    buffer_load_dwordx4 a[100:103], v103, s[28:31], 0 offen nt
    v_xor_b32 v103, s65, v103
    v_add_f32_dpp v90, v28, v30 row_ror:8 row_mask:0xf bank_mask:0x4
    v_add_f32_dpp v35, v32, v35 row_ror:12 row_mask:0xf bank_mask:0xf
    v_add_f32_dpp v33, v34, v33 row_ror:12 row_mask:0xf bank_mask:0xf
    s_waitcnt vmcnt(41)
    v_mfma_f32_16x16x32_bf16 v[28:31], a[104:107], v[8:11], 0
    buffer_load_dwordx4 a[104:107], v103, s[28:31], 0 offen nt
    v_xor_b32 v103, s62, v103
    v_add_f32_dpp v90, v33, v35 row_ror:8 row_mask:0xf bank_mask:0x8
    v_add_f32_dpp v20, v21, v20 row_ror:12 row_mask:0xf bank_mask:0xf
    v_add_f32_dpp v22, v23, v22 row_ror:12 row_mask:0xf bank_mask:0xf
    s_waitcnt vmcnt(41)
    v_mfma_f32_16x16x32_bf16 v[32:35], a[108:111], v[8:11], 0
    buffer_load_dwordx4 a[108:111], v103, s[28:31], 0 offen nt
    v_xor_b32 v103, s63, v103
    v_add_f32_dpp v91, v22, v20 row_ror:8 row_mask:0xf bank_mask:0x1
    v_add_f32_dpp v25, v26, v25 row_ror:12 row_mask:0xf bank_mask:0xf
    v_add_f32_dpp v27, v24, v27 row_ror:12 row_mask:0xf bank_mask:0xf
    s_waitcnt vmcnt(41)
    v_mfma_f32_16x16x32_bf16 v[20:23], a[112:115], v[8:11], 0
    buffer_load_dwordx4 a[112:115], v103, s[28:31], 0 offen nt
    v_xor_b32 v103, s62, v103
    s_waitcnt lgkmcnt(0)
    s_xor_b32 s19, s17, s16
    s_cmp_eq_u32 s23, 0
    s_cselect_b32 s19, 0, s19
    s_cmp_lg_u32 s19, 0
    s_cbranch_scc1 L_noclr2
    buffer_store_dwordx4 v[60:63], v3, s[48:51], s13 offen
L_noclr2:
    v_add_f32_dpp v91, v27, v25 row_ror:8 row_mask:0xf bank_mask:0x2
    v_add_f32_dpp v30, v31, v30 row_ror:12 row_mask:0xf bank_mask:0xf
    v_add_f32_dpp v28, v29, v28 row_ror:12 row_mask:0xf bank_mask:0xf
    s_waitcnt vmcnt(41)
    v_mfma_f32_16x16x32_bf16 v[24:27], a[116:119], v[8:11], 0
    buffer_load_dwordx4 a[116:119], v103, s[28:31], 0 offen nt
    v_xor_b32 v103, s64, v103
    v_add_f32_dpp v91, v28, v30 row_ror:8 row_mask:0xf bank_mask:0x4
    v_add_f32_dpp v35, v32, v35 row_ror:12 row_mask:0xf bank_mask:0xf
    v_add_f32_dpp v33, v34, v33 row_ror:12 row_mask:0xf bank_mask:0xf
    s_waitcnt vmcnt(41)
    v_mfma_f32_16x16x32_bf16 v[28:31], a[120:123], v[8:11], 0
    buffer_load_dwordx4 a[120:123], v103, s[28:31], 0 offen nt
    v_xor_b32 v103, s62, v103
    v_add_f32_dpp v91, v33, v35 row_ror:8 row_mask:0xf bank_mask:0x8
    v_add_f32_dpp v20, v21, v20 row_ror:12 row_mask:0xf bank_mask:0xf
    v_add_f32_dpp v22, v23, v22 row_ror:12 row_mask:0xf bank_mask:0xf
    s_waitcnt vmcnt(41)
    v_mfma_f32_16x16x32_bf16 v[32:35], a[124:127], v[8:11], 0
    buffer_load_dwordx4 a[124:127], v103, s[28:31], 0 offen nt
    v_xor_b32 v103, s63, v103
    v_add_f32_dpp v92, v22, v20 row_ror:8 row_mask:0xf bank_mask:0x1
    v_add_f32_dpp v25, v26, v25 row_ror:12 row_mask:0xf bank_mask:0xf
    v_add_f32_dpp v27, v24, v27 row_ror:12 row_mask:0xf bank_mask:0xf
    s_waitcnt vmcnt(41)
    v_mfma_f32_16x16x32_bf16 v[20:23], a[128:131], v[8:11], 0
    buffer_load_dwordx4 a[128:131], v103, s[28:31], 0 offen nt
    v_xor_b32 v103, s62, v103
    v_add_f32_dpp v92, v27, v25 row_ror:8 row_mask:0xf bank_mask:0x2
    v_max3_f32 v97, v97, v90, v91
    v_add_f32_dpp v30, v31, v30 row_ror:12 row_mask:0xf bank_mask:0xf
    v_add_f32_dpp v28, v29, v28 row_ror:12 row_mask:0xf bank_mask:0xf
    s_waitcnt vmcnt(41)
    v_mfma_f32_16x16x32_bf16 v[24:27], a[132:135], v[8:11], 0
    buffer_load_dwordx4 a[132:135], v103, s[28:31], 0 offen nt
    v_xor_b32 v103, s67, v103
    v_add_f32_dpp v92, v28, v30 row_ror:8 row_mask:0xf bank_mask:0x4
    v_add_f32_dpp v35, v32, v35 row_ror:12 row_mask:0xf bank_mask:0xf
    v_add_f32_dpp v33, v34, v33 row_ror:12 row_mask:0xf bank_mask:0xf
    s_waitcnt vmcnt(41)
    v_mfma_f32_16x16x32_bf16 v[28:31], a[136:139], v[8:11], 0
    buffer_load_dwordx4 a[136:139], v103, s[28:31], 0 offen nt
    v_xor_b32 v103, s62, v103
    v_add_f32_dpp v92, v33, v35 row_ror:8 row_mask:0xf bank_mask:0x8
    v_add_f32_dpp v20, v21, v20 row_ror:12 row_mask:0xf bank_mask:0xf
    v_add_f32_dpp v22, v23, v22 row_ror:12 row_mask:0xf bank_mask:0xf
    s_waitcnt vmcnt(41)
    v_mfma_f32_16x16x32_bf16 v[32:35], a[140:143], v[8:11], 0
    buffer_load_dwordx4 a[140:143], v103, s[28:31], 0 offen nt
    v_xor_b32 v103, s63, v103
    v_add_f32_dpp v93, v22, v20 row_ror:8 row_mask:0xf bank_mask:0x1
    v_add_f32_dpp v25, v26, v25 row_ror:12 row_mask:0xf bank_mask:0xf
    v_add_f32_dpp v27, v24, v27 row_ror:12 row_mask:0xf bank_mask:0xf
    s_waitcnt vmcnt(41)
    v_mfma_f32_16x16x32_bf16 v[20:23], a[144:147], v[8:11], 0
    buffer_load_dwordx4 a[144:147], v103, s[28:31], 0 offen nt
    v_xor_b32 v103, s62, v103
    v_add_f32_dpp v93, v27, v25 row_ror:8 row_mask:0xf bank_mask:0x2
    v_add_f32_dpp v30, v31, v30 row_ror:12 row_mask:0xf bank_mask:0xf
    v_add_f32_dpp v28, v29, v28 row_ror:12 row_mask:0xf bank_mask:0xf
    s_waitcnt vmcnt(41)
    v_mfma_f32_16x16x32_bf16 v[24:27], a[148:151], v[8:11], 0
    buffer_load_dwordx4 a[148:151], v103, s[28:31], 0 offen nt
    v_xor_b32 v103, s64, v103
    v_add_f32_dpp v93, v28, v30 row_ror:8 row_mask:0xf bank_mask:0x4
    v_add_f32_dpp v35, v32, v35 row_ror:12 row_mask:0xf bank_mask:0xf
    v_add_f32_dpp v33, v34, v33 row_ror:12 row_mask:0xf bank_mask:0xf
    s_waitcnt vmcnt(41)
    v_mfma_f32_16x16x32_bf16 v[28:31], a[152:155], v[8:11], 0
    buffer_load_dwordx4 a[152:155], v103, s[28:31], 0 offen nt
    v_xor_b32 v103, s62, v103
    v_add_f32_dpp v93, v33, v35 row_ror:8 row_mask:0xf bank_mask:0x8
    v_add_f32_dpp v20, v21, v20 row_ror:12 row_mask:0xf bank_mask:0xf
    v_add_f32_dpp v22, v23, v22 row_ror:12 row_mask:0xf bank_mask:0xf
    s_waitcnt vmcnt(41)
    v_mfma_f32_16x16x32_bf16 v[32:35], a[156:159], v[8:11], 0
    buffer_load_dwordx4 a[156:159], v103, s[28:31], 0 offen nt
    v_xor_b32 v103, s63, v103
    v_add_f32_dpp v94, v22, v20 row_ror:8 row_mask:0xf bank_mask:0x1
    v_add_f32_dpp v25, v26, v25 row_ror:12 row_mask:0xf bank_mask:0xf
    v_add_f32_dpp v27, v24, v27 row_ror:12 row_mask:0xf bank_mask:0xf
    s_waitcnt vmcnt(41)
    v_mfma_f32_16x16x32_bf16 v[20:23], a[160:163], v[8:11], 0
    buffer_load_dwordx4 a[160:163], v103, s[28:31], 0 offen nt
    v_xor_b32 v103, s62, v103
    v_add_f32_dpp v94, v27, v25 row_ror:8 row_mask:0xf bank_mask:0x2
    v_max3_f32 v97, v97, v92, v93
    v_add_f32_dpp v30, v31, v30 row_ror:12 row_mask:0xf bank_mask:0xf
    v_add_f32_dpp v28, v29, v28 row_ror:12 row_mask:0xf bank_mask:0xf
    s_waitcnt vmcnt(41)
    v_mfma_f32_16x16x32_bf16 v[24:27], a[164:167], v[8:11], 0
    buffer_load_dwordx4 a[164:167], v103, s[28:31], 0 offen nt
    v_xor_b32 v103, s65, v103
    v_add_f32_dpp v94, v28, v30 row_ror:8 row_mask:0xf bank_mask:0x4
    v_add_f32_dpp v35, v32, v35 row_ror:12 row_mask:0xf bank_mask:0xf
    v_add_f32_dpp v33, v34, v33 row_ror:12 row_mask:0xf bank_mask:0xf
    s_waitcnt vmcnt(41)
    v_mfma_f32_16x16x32_bf16 v[28:31], a[0:3], v[8:11], 0
    buffer_load_dwordx4 a[0:3], v103, s[28:31], 0 offen nt
    v_xor_b32 v103, s62, v103
    v_add_f32_dpp v94, v33, v35 row_ror:8 row_mask:0xf bank_mask:0x8
    v_add_f32_dpp v20, v21, v20 row_ror:12 row_mask:0xf bank_mask:0xf
    v_add_f32_dpp v22, v23, v22 row_ror:12 row_mask:0xf bank_mask:0xf
    s_waitcnt vmcnt(41)
    v_mfma_f32_16x16x32_bf16 v[32:35], a[4:7], v[8:11], 0
    buffer_load_dwordx4 a[4:7], v103, s[28:31], 0 offen nt
    v_xor_b32 v103, s63, v103
    v_add_f32_dpp v95, v22, v20 row_ror:8 row_mask:0xf bank_mask:0x1
    v_add_f32_dpp v25, v26, v25 row_ror:12 row_mask:0xf bank_mask:0xf
    v_add_f32_dpp v27, v24, v27 row_ror:12 row_mask:0xf bank_mask:0xf
    s_nop 1
    v_add_f32_dpp v95, v27, v25 row_ror:8 row_mask:0xf bank_mask:0x2
    v_add_f32_dpp v30, v31, v30 row_ror:12 row_mask:0xf bank_mask:0xf
    v_add_f32_dpp v28, v29, v28 row_ror:12 row_mask:0xf bank_mask:0xf
    s_nop 1
    v_add_f32_dpp v95, v28, v30 row_ror:8 row_mask:0xf bank_mask:0x4
    v_add_f32_dpp v35, v32, v35 row_ror:12 row_mask:0xf bank_mask:0xf
    v_add_f32_dpp v33, v34, v33 row_ror:12 row_mask:0xf bank_mask:0xf
    s_nop 1
    v_add_f32_dpp v95, v33, v35 row_ror:8 row_mask:0xf bank_mask:0x8
    s_cmp_lg_u32 s23, 2
    s_cbranch_scc1 L_notree1
    v_mfma_f32_16x16x32_bf16 v[20:23], v[44:47], v[8:11], 0
    s_and_b32 s4, s22, 16
    s_lshr_b32 s4, s56, s4
    s_lshl_b32 s4, s4, 16
    v_sub_f32 v36, 1.0, s4
    v_mul_f32 v36, 0xd028965f, v36
    s_nop 2
    v_add_f32_dpp v20, v21, v20 row_ror:12 row_mask:0xf bank_mask:0xf
    v_add_f32_dpp v22, v23, v22 row_ror:12 row_mask:0xf bank_mask:0xf
    v_add_f32 v20, v20, v36
    s_nop 1
    v_add_f32_dpp v96, v22, v20 row_ror:8 row_mask:0x1 bank_mask:0x1
L_notree1:
    v_max3_f32 v40, v97, v94, v95
    v_max_f32 v40, v40, v96
    s_nop 1
    v_max_f32_dpp v40, v40, v40 row_ror:8 row_mask:0xf bank_mask:0xf
    s_nop 1
    v_max_f32_dpp v40, v40, v40 row_ror:4 row_mask:0xf bank_mask:0xf
    v_mov_b32 v37, v40
    s_nop 1
    v_permlane16_swap_b32 v40, v37
    v_max_f32 v40, v40, v37
    v_mov_b32 v37, v40
    s_nop 1
    v_permlane32_swap_b32 v40, v37
    v_max_f32 v40, v40, v37
    v_mul_f32 v40, s8, v40
    v_fma_f32 v64, v64, s8, -v40
    v_fma_f32 v65, v65, s8, -v40
    v_exp_f32 v64, v64
    v_exp_f32 v65, v65
    s_nop 0
    v_add_f32 v41, v64, v65
    v_cvt_pk_bf16_f32 v64, v64, v64
    v_cvt_pk_bf16_f32 v65, v65, v65
    s_nop 0
    v_and_b32_dpp v52, v64, v12 quad_perm:[0,1,2,3] row_mask:0xf bank_mask:0xf
    v_and_b32_dpp v53, v64, v13 row_ror:4 row_mask:0xf bank_mask:0xf
    v_and_b32_dpp v54, v64, v14 row_ror:8 row_mask:0xf bank_mask:0xf
    v_and_b32_dpp v55, v64, v15 row_ror:12 row_mask:0xf bank_mask:0xf
    v_and_b32_dpp v56, v64, v12 row_ror:12 row_mask:0xf bank_mask:0xf
    v_and_b32_dpp v57, v64, v13 quad_perm:[0,1,2,3] row_mask:0xf bank_mask:0xf
    v_and_b32_dpp v58, v64, v14 row_ror:4 row_mask:0xf bank_mask:0xf
    v_and_b32_dpp v59, v64, v15 row_ror:8 row_mask:0xf bank_mask:0xf
    s_waitcnt vmcnt(41)
    v_mfma_f32_16x16x32_bf16 v[16:19], a[8:11], v[52:55], v[16:19]
    buffer_load_dwordx4 a[8:11], v103, s[28:31], 0 offen nt
    v_xor_b32 v103, s62, v103
    v_fma_f32 v66, v66, s8, -v40
    v_exp_f32 v66, v66
    s_nop 0
    v_add_f32 v41, v41, v66
    v_cvt_pk_bf16_f32 v66, v66, v66
    v_and_b32_dpp v60, v64, v12 row_ror:8 row_mask:0xf bank_mask:0xf
    v_and_b32_dpp v61, v64, v13 row_ror:12 row_mask:0xf bank_mask:0xf
    v_and_b32_dpp v62, v64, v14 quad_perm:[0,1,2,3] row_mask:0xf bank_mask:0xf
    v_and_b32_dpp v63, v64, v15 row_ror:4 row_mask:0xf bank_mask:0xf
    s_waitcnt vmcnt(41)
    v_mfma_f32_16x16x32_bf16 v[16:19], a[12:15], v[56:59], v[16:19]
    buffer_load_dwordx4 a[12:15], v103, s[28:31], 0 offen nt
    v_xor_b32 v103, s64, v103
    v_fma_f32 v67, v67, s8, -v40
    v_exp_f32 v67, v67
    s_nop 0
    v_add_f32 v41, v41, v67
    v_cvt_pk_bf16_f32 v67, v67, v67
    v_and_b32_dpp v52, v64, v12 row_ror:4 row_mask:0xf bank_mask:0xf
    v_and_b32_dpp v53, v64, v13 row_ror:8 row_mask:0xf bank_mask:0xf
    v_and_b32_dpp v54, v64, v14 row_ror:12 row_mask:0xf bank_mask:0xf
    v_and_b32_dpp v55, v64, v15 quad_perm:[0,1,2,3] row_mask:0xf bank_mask:0xf
    s_waitcnt vmcnt(41)
    v_mfma_f32_16x16x32_bf16 v[16:19], a[16:19], v[60:63], v[16:19]
    buffer_load_dwordx4 a[16:19], v103, s[28:31], 0 offen nt
    v_xor_b32 v103, s62, v103
    v_fma_f32 v68, v68, s8, -v40
    v_exp_f32 v68, v68
    s_nop 0
    v_add_f32 v41, v41, v68
    v_cvt_pk_bf16_f32 v68, v68, v68
    v_and_b32_dpp v56, v65, v12 quad_perm:[0,1,2,3] row_mask:0xf bank_mask:0xf
    v_and_b32_dpp v57, v65, v13 row_ror:4 row_mask:0xf bank_mask:0xf
    v_and_b32_dpp v58, v65, v14 row_ror:8 row_mask:0xf bank_mask:0xf
    v_and_b32_dpp v59, v65, v15 row_ror:12 row_mask:0xf bank_mask:0xf
    s_waitcnt vmcnt(41)
    v_mfma_f32_16x16x32_bf16 v[16:19], a[20:23], v[52:55], v[16:19]
    buffer_load_dwordx4 a[20:23], v103, s[28:31], 0 offen nt
    v_xor_b32 v103, s63, v103
    v_fma_f32 v69, v69, s8, -v40
    v_exp_f32 v69, v69
    s_nop 0
    v_add_f32 v41, v41, v69
    v_cvt_pk_bf16_f32 v69, v69, v69
    v_and_b32_dpp v60, v65, v12 row_ror:12 row_mask:0xf bank_mask:0xf
    v_and_b32_dpp v61, v65, v13 quad_perm:[0,1,2,3] row_mask:0xf bank_mask:0xf
    v_and_b32_dpp v62, v65, v14 row_ror:4 row_mask:0xf bank_mask:0xf
    v_and_b32_dpp v63, v65, v15 row_ror:8 row_mask:0xf bank_mask:0xf
    s_waitcnt vmcnt(41)
    v_mfma_f32_16x16x32_bf16 v[16:19], a[24:27], v[56:59], v[16:19]
    buffer_load_dwordx4 a[24:27], v103, s[28:31], 0 offen nt
    v_xor_b32 v103, s62, v103
    v_fma_f32 v70, v70, s8, -v40
    v_exp_f32 v70, v70
    s_nop 0
    v_add_f32 v41, v41, v70
    v_cvt_pk_bf16_f32 v70, v70, v70
    v_and_b32_dpp v52, v65, v12 row_ror:8 row_mask:0xf bank_mask:0xf
    v_and_b32_dpp v53, v65, v13 row_ror:12 row_mask:0xf bank_mask:0xf
    v_and_b32_dpp v54, v65, v14 quad_perm:[0,1,2,3] row_mask:0xf bank_mask:0xf
    v_and_b32_dpp v55, v65, v15 row_ror:4 row_mask:0xf bank_mask:0xf
    s_waitcnt vmcnt(41)
    v_mfma_f32_16x16x32_bf16 v[16:19], a[28:31], v[60:63], v[16:19]
    buffer_load_dwordx4 a[28:31], v103, s[28:31], 0 offen nt
    v_xor_b32 v103, s66, v103
    v_fma_f32 v71, v71, s8, -v40
    v_exp_f32 v71, v71
    s_nop 0
    v_add_f32 v41, v41, v71
    v_cvt_pk_bf16_f32 v71, v71, v71
    v_and_b32_dpp v56, v65, v12 row_ror:4 row_mask:0xf bank_mask:0xf
    v_and_b32_dpp v57, v65, v13 row_ror:8 row_mask:0xf bank_mask:0xf
    v_and_b32_dpp v58, v65, v14 row_ror:12 row_mask:0xf bank_mask:0xf
    v_and_b32_dpp v59, v65, v15 quad_perm:[0,1,2,3] row_mask:0xf bank_mask:0xf
    s_waitcnt vmcnt(41)
    v_mfma_f32_16x16x32_bf16 v[16:19], a[32:35], v[52:55], v[16:19]
    buffer_load_dwordx4 a[32:35], v103, s[28:31], 0 offen nt
    v_xor_b32 v103, s62, v103
    v_fma_f32 v72, v72, s8, -v40
    v_exp_f32 v72, v72
    s_nop 0
    v_add_f32 v41, v41, v72
    v_cvt_pk_bf16_f32 v72, v72, v72
    v_and_b32_dpp v60, v66, v12 quad_perm:[0,1,2,3] row_mask:0xf bank_mask:0xf
    v_and_b32_dpp v61, v66, v13 row_ror:4 row_mask:0xf bank_mask:0xf
    v_and_b32_dpp v62, v66, v14 row_ror:8 row_mask:0xf bank_mask:0xf
    v_and_b32_dpp v63, v66, v15 row_ror:12 row_mask:0xf bank_mask:0xf
    s_waitcnt vmcnt(41)
    v_mfma_f32_16x16x32_bf16 v[16:19], a[36:39], v[56:59], v[16:19]
    buffer_load_dwordx4 a[36:39], v103, s[28:31], 0 offen nt
    v_xor_b32 v103, s63, v103
    v_fma_f32 v73, v73, s8, -v40
    v_exp_f32 v73, v73
    s_nop 0
    v_add_f32 v41, v41, v73
    v_cvt_pk_bf16_f32 v73, v73, v73
    v_and_b32_dpp v52, v66, v12 row_ror:12 row_mask:0xf bank_mask:0xf
    v_and_b32_dpp v53, v66, v13 quad_perm:[0,1,2,3] row_mask:0xf bank_mask:0xf
    v_and_b32_dpp v54, v66, v14 row_ror:4 row_mask:0xf bank_mask:0xf
    v_and_b32_dpp v55, v66, v15 row_ror:8 row_mask:0xf bank_mask:0xf
    s_waitcnt vmcnt(41)
    v_mfma_f32_16x16x32_bf16 v[16:19], a[40:43], v[60:63], v[16:19]
    buffer_load_dwordx4 a[40:43], v103, s[28:31], 0 offen nt
    v_xor_b32 v103, s62, v103
    v_fma_f32 v74, v74, s8, -v40
    v_exp_f32 v74, v74
    s_nop 0
    v_add_f32 v41, v41, v74
    v_cvt_pk_bf16_f32 v74, v74, v74
    v_and_b32_dpp v56, v66, v12 row_ror:8 row_mask:0xf bank_mask:0xf
    v_and_b32_dpp v57, v66, v13 row_ror:12 row_mask:0xf bank_mask:0xf
    v_and_b32_dpp v58, v66, v14 quad_perm:[0,1,2,3] row_mask:0xf bank_mask:0xf
    v_and_b32_dpp v59, v66, v15 row_ror:4 row_mask:0xf bank_mask:0xf
    s_waitcnt vmcnt(41)
    v_mfma_f32_16x16x32_bf16 v[16:19], a[44:47], v[52:55], v[16:19]
    buffer_load_dwordx4 a[44:47], v103, s[28:31], 0 offen nt
    v_xor_b32 v103, s64, v103
    v_fma_f32 v75, v75, s8, -v40
    v_exp_f32 v75, v75
    s_nop 0
    v_add_f32 v41, v41, v75
    v_cvt_pk_bf16_f32 v75, v75, v75
    v_and_b32_dpp v60, v66, v12 row_ror:4 row_mask:0xf bank_mask:0xf
    v_and_b32_dpp v61, v66, v13 row_ror:8 row_mask:0xf bank_mask:0xf
    v_and_b32_dpp v62, v66, v14 row_ror:12 row_mask:0xf bank_mask:0xf
    v_and_b32_dpp v63, v66, v15 quad_perm:[0,1,2,3] row_mask:0xf bank_mask:0xf
    s_waitcnt vmcnt(41)
    v_mfma_f32_16x16x32_bf16 v[16:19], a[48:51], v[56:59], v[16:19]
    buffer_load_dwordx4 a[48:51], v103, s[28:31], 0 offen nt
    v_xor_b32 v103, s62, v103
    v_fma_f32 v76, v76, s8, -v40
    v_exp_f32 v76, v76
    s_nop 0
    v_add_f32 v41, v41, v76
    v_cvt_pk_bf16_f32 v76, v76, v76
    v_and_b32_dpp v52, v67, v12 quad_perm:[0,1,2,3] row_mask:0xf bank_mask:0xf
    v_and_b32_dpp v53, v67, v13 row_ror:4 row_mask:0xf bank_mask:0xf
    v_and_b32_dpp v54, v67, v14 row_ror:8 row_mask:0xf bank_mask:0xf
    v_and_b32_dpp v55, v67, v15 row_ror:12 row_mask:0xf bank_mask:0xf
    s_waitcnt vmcnt(41)
    v_mfma_f32_16x16x32_bf16 v[16:19], a[52:55], v[60:63], v[16:19]
    buffer_load_dwordx4 a[52:55], v103, s[28:31], 0 offen nt
    v_xor_b32 v103, s63, v103
    v_fma_f32 v77, v77, s8, -v40
    v_exp_f32 v77, v77
    s_nop 0
    v_add_f32 v41, v41, v77
    v_cvt_pk_bf16_f32 v77, v77, v77
    v_and_b32_dpp v56, v67, v12 row_ror:12 row_mask:0xf bank_mask:0xf
    v_and_b32_dpp v57, v67, v13 quad_perm:[0,1,2,3] row_mask:0xf bank_mask:0xf
    v_and_b32_dpp v58, v67, v14 row_ror:4 row_mask:0xf bank_mask:0xf
    v_and_b32_dpp v59, v67, v15 row_ror:8 row_mask:0xf bank_mask:0xf
    s_waitcnt vmcnt(41)
    v_mfma_f32_16x16x32_bf16 v[16:19], a[56:59], v[52:55], v[16:19]
    buffer_load_dwordx4 a[56:59], v103, s[28:31], 0 offen nt
    v_xor_b32 v103, s62, v103
    v_fma_f32 v78, v78, s8, -v40
    v_exp_f32 v78, v78
    s_nop 0
    v_add_f32 v41, v41, v78
    v_cvt_pk_bf16_f32 v78, v78, v78
    v_and_b32_dpp v60, v67, v12 row_ror:8 row_mask:0xf bank_mask:0xf
    v_and_b32_dpp v61, v67, v13 row_ror:12 row_mask:0xf bank_mask:0xf
    v_and_b32_dpp v62, v67, v14 quad_perm:[0,1,2,3] row_mask:0xf bank_mask:0xf
    v_and_b32_dpp v63, v67, v15 row_ror:4 row_mask:0xf bank_mask:0xf
    s_waitcnt vmcnt(41)
    v_mfma_f32_16x16x32_bf16 v[16:19], a[60:63], v[56:59], v[16:19]
    buffer_load_dwordx4 a[60:63], v103, s[28:31], 0 offen nt
    v_xor_b32 v103, s65, v103
    v_fma_f32 v79, v79, s8, -v40
    v_exp_f32 v79, v79
    s_nop 0
    v_add_f32 v41, v41, v79
    v_cvt_pk_bf16_f32 v79, v79, v79
    v_and_b32_dpp v52, v67, v12 row_ror:4 row_mask:0xf bank_mask:0xf
    v_and_b32_dpp v53, v67, v13 row_ror:8 row_mask:0xf bank_mask:0xf
    v_and_b32_dpp v54, v67, v14 row_ror:12 row_mask:0xf bank_mask:0xf
    v_and_b32_dpp v55, v67, v15 quad_perm:[0,1,2,3] row_mask:0xf bank_mask:0xf
    s_waitcnt vmcnt(41)
    v_mfma_f32_16x16x32_bf16 v[16:19], a[64:67], v[60:63], v[16:19]
    buffer_load_dwordx4 a[64:67], v103, s[28:31], 0 offen nt
    v_xor_b32 v103, s62, v103
    v_fma_f32 v80, v80, s8, -v40
    v_exp_f32 v80, v80
    s_nop 0
    v_add_f32 v41, v41, v80
    v_cvt_pk_bf16_f32 v80, v80, v80
    v_and_b32_dpp v56, v68, v12 quad_perm:[0,1,2,3] row_mask:0xf bank_mask:0xf
    v_and_b32_dpp v57, v68, v13 row_ror:4 row_mask:0xf bank_mask:0xf
    v_and_b32_dpp v58, v68, v14 row_ror:8 row_mask:0xf bank_mask:0xf
    v_and_b32_dpp v59, v68, v15 row_ror:12 row_mask:0xf bank_mask:0xf
    s_waitcnt vmcnt(41)
    v_mfma_f32_16x16x32_bf16 v[16:19], a[68:71], v[52:55], v[16:19]
    buffer_load_dwordx4 a[68:71], v103, s[28:31], 0 offen nt
    v_xor_b32 v103, s63, v103
    v_fma_f32 v81, v81, s8, -v40
    v_exp_f32 v81, v81
    s_nop 0
    v_add_f32 v41, v41, v81
    v_cvt_pk_bf16_f32 v81, v81, v81
    v_and_b32_dpp v60, v68, v12 row_ror:12 row_mask:0xf bank_mask:0xf
    v_and_b32_dpp v61, v68, v13 quad_perm:[0,1,2,3] row_mask:0xf bank_mask:0xf
    v_and_b32_dpp v62, v68, v14 row_ror:4 row_mask:0xf bank_mask:0xf
    v_and_b32_dpp v63, v68, v15 row_ror:8 row_mask:0xf bank_mask:0xf
    s_waitcnt vmcnt(41)
    v_mfma_f32_16x16x32_bf16 v[16:19], a[72:75], v[56:59], v[16:19]
    buffer_load_dwordx4 a[72:75], v103, s[28:31], 0 offen nt
    v_xor_b32 v103, s62, v103
    v_fma_f32 v82, v82, s8, -v40
    v_exp_f32 v82, v82
    s_nop 0
    v_add_f32 v41, v41, v82
    v_cvt_pk_bf16_f32 v82, v82, v82
    v_and_b32_dpp v52, v68, v12 row_ror:8 row_mask:0xf bank_mask:0xf
    v_and_b32_dpp v53, v68, v13 row_ror:12 row_mask:0xf bank_mask:0xf
    v_and_b32_dpp v54, v68, v14 quad_perm:[0,1,2,3] row_mask:0xf bank_mask:0xf
    v_and_b32_dpp v55, v68, v15 row_ror:4 row_mask:0xf bank_mask:0xf
    s_waitcnt vmcnt(41)
    v_mfma_f32_16x16x32_bf16 v[16:19], a[76:79], v[60:63], v[16:19]
    buffer_load_dwordx4 a[76:79], v103, s[28:31], 0 offen nt
    v_xor_b32 v103, s64, v103
    v_fma_f32 v83, v83, s8, -v40
    v_exp_f32 v83, v83
    s_nop 0
    v_add_f32 v41, v41, v83
    v_cvt_pk_bf16_f32 v83, v83, v83
    v_and_b32_dpp v56, v68, v12 row_ror:4 row_mask:0xf bank_mask:0xf
    v_and_b32_dpp v57, v68, v13 row_ror:8 row_mask:0xf bank_mask:0xf
    v_and_b32_dpp v58, v68, v14 row_ror:12 row_mask:0xf bank_mask:0xf
    v_and_b32_dpp v59, v68, v15 quad_perm:[0,1,2,3] row_mask:0xf bank_mask:0xf
    s_waitcnt vmcnt(41)
    v_mfma_f32_16x16x32_bf16 v[16:19], a[80:83], v[52:55], v[16:19]
    buffer_load_dwordx4 a[80:83], v103, s[28:31], 0 offen nt
    v_xor_b32 v103, s62, v103
    v_fma_f32 v84, v84, s8, -v40
    v_exp_f32 v84, v84
    s_nop 0
    v_add_f32 v41, v41, v84
    v_cvt_pk_bf16_f32 v84, v84, v84
    v_and_b32_dpp v60, v69, v12 quad_perm:[0,1,2,3] row_mask:0xf bank_mask:0xf
    v_and_b32_dpp v61, v69, v13 row_ror:4 row_mask:0xf bank_mask:0xf
    v_and_b32_dpp v62, v69, v14 row_ror:8 row_mask:0xf bank_mask:0xf
    v_and_b32_dpp v63, v69, v15 row_ror:12 row_mask:0xf bank_mask:0xf
    s_waitcnt vmcnt(41)
    v_mfma_f32_16x16x32_bf16 v[16:19], a[84:87], v[56:59], v[16:19]
    buffer_load_dwordx4 a[84:87], v103, s[28:31], 0 offen nt
    v_xor_b32 v103, s63, v103
    v_fma_f32 v85, v85, s8, -v40
    v_exp_f32 v85, v85
    s_nop 0
    v_add_f32 v41, v41, v85
    v_cvt_pk_bf16_f32 v85, v85, v85
    v_and_b32_dpp v52, v69, v12 row_ror:12 row_mask:0xf bank_mask:0xf
    v_and_b32_dpp v53, v69, v13 quad_perm:[0,1,2,3] row_mask:0xf bank_mask:0xf
    v_and_b32_dpp v54, v69, v14 row_ror:4 row_mask:0xf bank_mask:0xf
    v_and_b32_dpp v55, v69, v15 row_ror:8 row_mask:0xf bank_mask:0xf
    s_waitcnt vmcnt(41)
    v_mfma_f32_16x16x32_bf16 v[16:19], a[88:91], v[60:63], v[16:19]
    buffer_load_dwordx4 a[88:91], v103, s[28:31], 0 offen nt
    v_xor_b32 v103, s62, v103
    v_fma_f32 v86, v86, s8, -v40
    v_exp_f32 v86, v86
    s_nop 0
    v_add_f32 v41, v41, v86
    v_cvt_pk_bf16_f32 v86, v86, v86
    v_and_b32_dpp v56, v69, v12 row_ror:8 row_mask:0xf bank_mask:0xf
    v_and_b32_dpp v57, v69, v13 row_ror:12 row_mask:0xf bank_mask:0xf
    v_and_b32_dpp v58, v69, v14 quad_perm:[0,1,2,3] row_mask:0xf bank_mask:0xf
    v_and_b32_dpp v59, v69, v15 row_ror:4 row_mask:0xf bank_mask:0xf
    s_waitcnt vmcnt(41)
    v_mfma_f32_16x16x32_bf16 v[16:19], a[92:95], v[52:55], v[16:19]
    buffer_load_dwordx4 a[92:95], v103, s[28:31], 0 offen nt
    v_xor_b32 v103, s68, v103
    v_fma_f32 v87, v87, s8, -v40
    v_exp_f32 v87, v87
    s_nop 0
    v_add_f32 v41, v41, v87
    v_cvt_pk_bf16_f32 v87, v87, v87
    v_and_b32_dpp v60, v69, v12 row_ror:4 row_mask:0xf bank_mask:0xf
    v_and_b32_dpp v61, v69, v13 row_ror:8 row_mask:0xf bank_mask:0xf
    v_and_b32_dpp v62, v69, v14 row_ror:12 row_mask:0xf bank_mask:0xf
    v_and_b32_dpp v63, v69, v15 quad_perm:[0,1,2,3] row_mask:0xf bank_mask:0xf
    s_waitcnt vmcnt(41)
    v_mfma_f32_16x16x32_bf16 v[16:19], a[96:99], v[56:59], v[16:19]
    buffer_load_dwordx4 a[96:99], v103, s[28:31], 0 offen nt
    v_xor_b32 v103, s62, v103
    v_fma_f32 v88, v88, s8, -v40
    v_exp_f32 v88, v88
    s_nop 0
    v_add_f32 v41, v41, v88
    v_cvt_pk_bf16_f32 v88, v88, v88
    v_and_b32_dpp v52, v70, v12 quad_perm:[0,1,2,3] row_mask:0xf bank_mask:0xf
    v_and_b32_dpp v53, v70, v13 row_ror:4 row_mask:0xf bank_mask:0xf
    v_and_b32_dpp v54, v70, v14 row_ror:8 row_mask:0xf bank_mask:0xf
    v_and_b32_dpp v55, v70, v15 row_ror:12 row_mask:0xf bank_mask:0xf
    s_waitcnt vmcnt(41)
    v_mfma_f32_16x16x32_bf16 v[16:19], a[100:103], v[60:63], v[16:19]
    buffer_load_dwordx4 a[100:103], v103, s[28:31], 0 offen nt
    v_xor_b32 v103, s63, v103
    v_fma_f32 v89, v89, s8, -v40
    v_exp_f32 v89, v89
    s_nop 0
    v_add_f32 v41, v41, v89
    v_cvt_pk_bf16_f32 v89, v89, v89
    v_and_b32_dpp v56, v70, v12 row_ror:12 row_mask:0xf bank_mask:0xf
    v_and_b32_dpp v57, v70, v13 quad_perm:[0,1,2,3] row_mask:0xf bank_mask:0xf
    v_and_b32_dpp v58, v70, v14 row_ror:4 row_mask:0xf bank_mask:0xf
    v_and_b32_dpp v59, v70, v15 row_ror:8 row_mask:0xf bank_mask:0xf
    s_waitcnt vmcnt(41)
    v_mfma_f32_16x16x32_bf16 v[16:19], a[104:107], v[52:55], v[16:19]
    buffer_load_dwordx4 a[104:107], v103, s[28:31], 0 offen nt
    v_xor_b32 v103, s62, v103
    v_fma_f32 v90, v90, s8, -v40
    v_exp_f32 v90, v90
    s_nop 0
    v_add_f32 v41, v41, v90
    v_cvt_pk_bf16_f32 v90, v90, v90
    v_and_b32_dpp v60, v70, v12 row_ror:8 row_mask:0xf bank_mask:0xf
    v_and_b32_dpp v61, v70, v13 row_ror:12 row_mask:0xf bank_mask:0xf
    v_and_b32_dpp v62, v70, v14 quad_perm:[0,1,2,3] row_mask:0xf bank_mask:0xf
    v_and_b32_dpp v63, v70, v15 row_ror:4 row_mask:0xf bank_mask:0xf
    s_waitcnt vmcnt(41)
    v_mfma_f32_16x16x32_bf16 v[16:19], a[108:111], v[56:59], v[16:19]
    buffer_load_dwordx4 a[108:111], v103, s[28:31], 0 offen nt
    v_xor_b32 v103, s64, v103
    v_fma_f32 v91, v91, s8, -v40
    v_exp_f32 v91, v91
    s_nop 0
    v_add_f32 v41, v41, v91
    v_cvt_pk_bf16_f32 v91, v91, v91
    v_and_b32_dpp v52, v70, v12 row_ror:4 row_mask:0xf bank_mask:0xf
    v_and_b32_dpp v53, v70, v13 row_ror:8 row_mask:0xf bank_mask:0xf
    v_and_b32_dpp v54, v70, v14 row_ror:12 row_mask:0xf bank_mask:0xf
    v_and_b32_dpp v55, v70, v15 quad_perm:[0,1,2,3] row_mask:0xf bank_mask:0xf
    s_waitcnt vmcnt(41)
    v_mfma_f32_16x16x32_bf16 v[16:19], a[112:115], v[60:63], v[16:19]
    buffer_load_dwordx4 a[112:115], v103, s[28:31], 0 offen nt
    v_xor_b32 v103, s62, v103
    v_fma_f32 v92, v92, s8, -v40
    v_exp_f32 v92, v92
    s_nop 0
    v_add_f32 v41, v41, v92
    v_cvt_pk_bf16_f32 v92, v92, v92
    v_and_b32_dpp v56, v71, v12 quad_perm:[0,1,2,3] row_mask:0xf bank_mask:0xf
    v_and_b32_dpp v57, v71, v13 row_ror:4 row_mask:0xf bank_mask:0xf
    v_and_b32_dpp v58, v71, v14 row_ror:8 row_mask:0xf bank_mask:0xf
    v_and_b32_dpp v59, v71, v15 row_ror:12 row_mask:0xf bank_mask:0xf
    s_waitcnt vmcnt(41)
    v_mfma_f32_16x16x32_bf16 v[16:19], a[116:119], v[52:55], v[16:19]
    buffer_load_dwordx4 a[116:119], v103, s[28:31], 0 offen nt
    v_xor_b32 v103, s63, v103
    v_fma_f32 v93, v93, s8, -v40
    v_exp_f32 v93, v93
    s_nop 0
    v_add_f32 v41, v41, v93
    v_cvt_pk_bf16_f32 v93, v93, v93
    v_and_b32_dpp v60, v71, v12 row_ror:12 row_mask:0xf bank_mask:0xf
    v_and_b32_dpp v61, v71, v13 quad_perm:[0,1,2,3] row_mask:0xf bank_mask:0xf
    v_and_b32_dpp v62, v71, v14 row_ror:4 row_mask:0xf bank_mask:0xf
    v_and_b32_dpp v63, v71, v15 row_ror:8 row_mask:0xf bank_mask:0xf
    s_waitcnt vmcnt(41)
    v_mfma_f32_16x16x32_bf16 v[16:19], a[120:123], v[56:59], v[16:19]
    buffer_load_dwordx4 a[120:123], v103, s[28:31], 0 offen nt
    v_xor_b32 v103, s62, v103
    v_fma_f32 v94, v94, s8, -v40
    v_exp_f32 v94, v94
    s_nop 0
    v_add_f32 v41, v41, v94
    v_cvt_pk_bf16_f32 v94, v94, v94
    v_and_b32_dpp v52, v71, v12 row_ror:8 row_mask:0xf bank_mask:0xf
    v_and_b32_dpp v53, v71, v13 row_ror:12 row_mask:0xf bank_mask:0xf
    v_and_b32_dpp v54, v71, v14 quad_perm:[0,1,2,3] row_mask:0xf bank_mask:0xf
    v_and_b32_dpp v55, v71, v15 row_ror:4 row_mask:0xf bank_mask:0xf
    s_waitcnt vmcnt(41)
    v_mfma_f32_16x16x32_bf16 v[16:19], a[124:127], v[60:63], v[16:19]
    buffer_load_dwordx4 a[124:127], v103, s[28:31], 0 offen nt
    v_xor_b32 v103, s65, v103
    v_fma_f32 v95, v95, s8, -v40
    v_exp_f32 v95, v95
    s_nop 0
    v_add_f32 v41, v41, v95
    v_cvt_pk_bf16_f32 v95, v95, v95
    v_and_b32_dpp v56, v71, v12 row_ror:4 row_mask:0xf bank_mask:0xf
    v_and_b32_dpp v57, v71, v13 row_ror:8 row_mask:0xf bank_mask:0xf
    v_and_b32_dpp v58, v71, v14 row_ror:12 row_mask:0xf bank_mask:0xf
    v_and_b32_dpp v59, v71, v15 quad_perm:[0,1,2,3] row_mask:0xf bank_mask:0xf
    s_waitcnt vmcnt(41)
    v_mfma_f32_16x16x32_bf16 v[16:19], a[128:131], v[52:55], v[16:19]
    buffer_load_dwordx4 a[128:131], v103, s[28:31], 0 offen nt
    v_xor_b32 v103, s62, v103
    v_fma_f32 v96, v96, s8, -v40
    v_exp_f32 v96, v96
    s_nop 0
    v_add_f32 v41, v41, v96
    v_cvt_pk_bf16_f32 v96, v96, v96
    s_nop 0
    v_add_f32_dpp v41, v41, v41 row_ror:8 row_mask:0xf bank_mask:0xf
    s_nop 1
    v_add_f32_dpp v41, v41, v41 row_ror:4 row_mask:0xf bank_mask:0xf
    v_mov_b32 v37, v41
    s_nop 1
    v_permlane16_swap_b32 v41, v37
    v_add_f32 v41, v41, v37
    v_mov_b32 v37, v41
    s_nop 1
    v_permlane32_swap_b32 v41, v37
    v_add_f32 v41, v41, v37
    s_cmp_lg_u32 s23, 2
    s_cbranch_scc1 L_notree2
    v_and_b32_dpp v44, v96, v12 quad_perm:[0,1,2,3] row_mask:0xf bank_mask:0xf
    v_and_b32_dpp v45, v96, v13 row_ror:4 row_mask:0xf bank_mask:0xf
    v_and_b32_dpp v46, v96, v14 row_ror:8 row_mask:0xf bank_mask:0xf
    v_and_b32_dpp v47, v96, v15 row_ror:12 row_mask:0xf bank_mask:0xf
    s_nop 1
    v_mfma_f32_16x16x32_bf16 v[16:19], v[48:51], v[44:47], v[16:19]
L_notree2:
    v_and_b32_dpp v60, v72, v12 quad_perm:[0,1,2,3] row_mask:0xf bank_mask:0xf
    v_and_b32_dpp v61, v72, v13 row_ror:4 row_mask:0xf bank_mask:0xf
    v_and_b32_dpp v62, v72, v14 row_ror:8 row_mask:0xf bank_mask:0xf
    v_and_b32_dpp v63, v72, v15 row_ror:12 row_mask:0xf bank_mask:0xf
    s_waitcnt vmcnt(41)
    v_mfma_f32_16x16x32_bf16 v[16:19], a[132:135], v[56:59], v[16:19]
    buffer_load_dwordx4 a[132:135], v103, s[28:31], 0 offen nt
    v_xor_b32 v103, s63, v103
    v_min_u32 v40, -2, v40
    v_min_u32 v41, -2, v41
    s_mov_b64 exec, 5
    s_cmp_lg_u32 s19, 0
    s_cbranch_scc1 L_ml_remote
    buffer_store_dwordx2 v[40:41], v5, s[48:51], s9 offen
L_ml_sent:
    s_mov_b64 exec, -1
    v_and_b32_dpp v52, v72, v12 row_ror:12 row_mask:0xf bank_mask:0xf
    v_and_b32_dpp v53, v72, v13 quad_perm:[0,1,2,3] row_mask:0xf bank_mask:0xf
    v_and_b32_dpp v54, v72, v14 row_ror:4 row_mask:0xf bank_mask:0xf
    v_and_b32_dpp v55, v72, v15 row_ror:8 row_mask:0xf bank_mask:0xf
    s_waitcnt vmcnt(42)
    v_mfma_f32_16x16x32_bf16 v[16:19], a[136:139], v[60:63], v[16:19]
    buffer_load_dwordx4 a[136:139], v103, s[28:31], 0 offen nt
    v_xor_b32 v103, s62, v103
    v_and_b32_dpp v56, v72, v12 row_ror:8 row_mask:0xf bank_mask:0xf
    v_and_b32_dpp v57, v72, v13 row_ror:12 row_mask:0xf bank_mask:0xf
    v_and_b32_dpp v58, v72, v14 quad_perm:[0,1,2,3] row_mask:0xf bank_mask:0xf
    v_and_b32_dpp v59, v72, v15 row_ror:4 row_mask:0xf bank_mask:0xf
    s_waitcnt vmcnt(42)
    v_mfma_f32_16x16x32_bf16 v[16:19], a[140:143], v[52:55], v[16:19]
    buffer_load_dwordx4 a[140:143], v103, s[28:31], 0 offen nt
    v_xor_b32 v103, s64, v103
    v_and_b32_dpp v60, v72, v12 row_ror:4 row_mask:0xf bank_mask:0xf
    v_and_b32_dpp v61, v72, v13 row_ror:8 row_mask:0xf bank_mask:0xf
    v_and_b32_dpp v62, v72, v14 row_ror:12 row_mask:0xf bank_mask:0xf
    v_and_b32_dpp v63, v72, v15 quad_perm:[0,1,2,3] row_mask:0xf bank_mask:0xf
    s_waitcnt vmcnt(42)
    v_mfma_f32_16x16x32_bf16 v[16:19], a[144:147], v[56:59], v[16:19]
    buffer_load_dwordx4 a[144:147], v103, s[28:31], 0 offen nt
    v_xor_b32 v103, s62, v103
    v_and_b32_dpp v52, v73, v12 quad_perm:[0,1,2,3] row_mask:0xf bank_mask:0xf
    v_and_b32_dpp v53, v73, v13 row_ror:4 row_mask:0xf bank_mask:0xf
    v_and_b32_dpp v54, v73, v14 row_ror:8 row_mask:0xf bank_mask:0xf
    v_and_b32_dpp v55, v73, v15 row_ror:12 row_mask:0xf bank_mask:0xf
    s_waitcnt vmcnt(42)
    v_mfma_f32_16x16x32_bf16 v[16:19], a[148:151], v[60:63], v[16:19]
    buffer_load_dwordx4 a[148:151], v103, s[28:31], 0 offen nt
    v_xor_b32 v103, s63, v103
    v_and_b32_dpp v56, v73, v12 row_ror:12 row_mask:0xf bank_mask:0xf
    v_and_b32_dpp v57, v73, v13 quad_perm:[0,1,2,3] row_mask:0xf bank_mask:0xf
    v_and_b32_dpp v58, v73, v14 row_ror:4 row_mask:0xf bank_mask:0xf
    v_and_b32_dpp v59, v73, v15 row_ror:8 row_mask:0xf bank_mask:0xf
    s_waitcnt vmcnt(42)
    v_mfma_f32_16x16x32_bf16 v[16:19], a[152:155], v[52:55], v[16:19]
    buffer_load_dwordx4 a[152:155], v103, s[28:31], 0 offen nt
    v_xor_b32 v103, s62, v103
    v_and_b32_dpp v60, v73, v12 row_ror:8 row_mask:0xf bank_mask:0xf
    v_and_b32_dpp v61, v73, v13 row_ror:12 row_mask:0xf bank_mask:0xf
    v_and_b32_dpp v62, v73, v14 quad_perm:[0,1,2,3] row_mask:0xf bank_mask:0xf
    v_and_b32_dpp v63, v73, v15 row_ror:4 row_mask:0xf bank_mask:0xf
    s_waitcnt vmcnt(42)
    v_mfma_f32_16x16x32_bf16 v[16:19], a[156:159], v[56:59], v[16:19]
    buffer_load_dwordx4 a[156:159], v103, s[28:31], 0 offen nt
    v_xor_b32 v103, s66, v103
    v_and_b32_dpp v52, v73, v12 row_ror:4 row_mask:0xf bank_mask:0xf
    v_and_b32_dpp v53, v73, v13 row_ror:8 row_mask:0xf bank_mask:0xf
    v_and_b32_dpp v54, v73, v14 row_ror:12 row_mask:0xf bank_mask:0xf
    v_and_b32_dpp v55, v73, v15 quad_perm:[0,1,2,3] row_mask:0xf bank_mask:0xf
    s_waitcnt vmcnt(42)
    v_mfma_f32_16x16x32_bf16 v[16:19], a[160:163], v[60:63], v[16:19]
    buffer_load_dwordx4 a[160:163], v103, s[28:31], 0 offen nt
    v_xor_b32 v103, s62, v103
    v_and_b32_dpp v56, v74, v12 quad_perm:[0,1,2,3] row_mask:0xf bank_mask:0xf
    v_and_b32_dpp v57, v74, v13 row_ror:4 row_mask:0xf bank_mask:0xf
    v_and_b32_dpp v58, v74, v14 row_ror:8 row_mask:0xf bank_mask:0xf
    v_and_b32_dpp v59, v74, v15 row_ror:12 row_mask:0xf bank_mask:0xf
    s_waitcnt vmcnt(42)
    v_mfma_f32_16x16x32_bf16 v[16:19], a[164:167], v[52:55], v[16:19]
    buffer_load_dwordx4 a[164:167], v103, s[28:31], 0 offen nt
    v_xor_b32 v103, s63, v103
    v_and_b32_dpp v60, v74, v12 row_ror:12 row_mask:0xf bank_mask:0xf
    v_and_b32_dpp v61, v74, v13 quad_perm:[0,1,2,3] row_mask:0xf bank_mask:0xf
    v_and_b32_dpp v62, v74, v14 row_ror:4 row_mask:0xf bank_mask:0xf
    v_and_b32_dpp v63, v74, v15 row_ror:8 row_mask:0xf bank_mask:0xf
    s_waitcnt vmcnt(42)
    v_mfma_f32_16x16x32_bf16 v[16:19], a[0:3], v[56:59], v[16:19]
    buffer_load_dwordx4 a[0:3], v103, s[28:31], 0 offen nt
    v_xor_b32 v103, s62, v103
    v_and_b32_dpp v52, v74, v12 row_ror:8 row_mask:0xf bank_mask:0xf
    v_and_b32_dpp v53, v74, v13 row_ror:12 row_mask:0xf bank_mask:0xf
    v_and_b32_dpp v54, v74, v14 quad_perm:[0,1,2,3] row_mask:0xf bank_mask:0xf
    v_and_b32_dpp v55, v74, v15 row_ror:4 row_mask:0xf bank_mask:0xf
    s_waitcnt vmcnt(42)
    v_mfma_f32_16x16x32_bf16 v[16:19], a[4:7], v[60:63], v[16:19]
    buffer_load_dwordx4 a[4:7], v103, s[28:31], 0 offen nt
    v_xor_b32 v103, s64, v103
    v_and_b32_dpp v56, v74, v12 row_ror:4 row_mask:0xf bank_mask:0xf
    v_and_b32_dpp v57, v74, v13 row_ror:8 row_mask:0xf bank_mask:0xf
    v_and_b32_dpp v58, v74, v14 row_ror:12 row_mask:0xf bank_mask:0xf
    v_and_b32_dpp v59, v74, v15 quad_perm:[0,1,2,3] row_mask:0xf bank_mask:0xf
    s_waitcnt vmcnt(42)
    v_mfma_f32_16x16x32_bf16 v[16:19], a[8:11], v[52:55], v[16:19]
    buffer_load_dwordx4 a[8:11], v103, s[28:31], 0 offen nt
    v_xor_b32 v103, s62, v103
    v_and_b32_dpp v60, v75, v12 quad_perm:[0,1,2,3] row_mask:0xf bank_mask:0xf
    v_and_b32_dpp v61, v75, v13 row_ror:4 row_mask:0xf bank_mask:0xf
    v_and_b32_dpp v62, v75, v14 row_ror:8 row_mask:0xf bank_mask:0xf
    v_and_b32_dpp v63, v75, v15 row_ror:12 row_mask:0xf bank_mask:0xf
    s_waitcnt vmcnt(42)
    v_mfma_f32_16x16x32_bf16 v[16:19], a[12:15], v[56:59], v[16:19]
    buffer_load_dwordx4 a[12:15], v103, s[28:31], 0 offen nt
    v_xor_b32 v103, s63, v103
    v_and_b32_dpp v52, v75, v12 row_ror:12 row_mask:0xf bank_mask:0xf
    v_and_b32_dpp v53, v75, v13 quad_perm:[0,1,2,3] row_mask:0xf bank_mask:0xf
    v_and_b32_dpp v54, v75, v14 row_ror:4 row_mask:0xf bank_mask:0xf
    v_and_b32_dpp v55, v75, v15 row_ror:8 row_mask:0xf bank_mask:0xf
    s_waitcnt vmcnt(42)
    v_mfma_f32_16x16x32_bf16 v[16:19], a[16:19], v[60:63], v[16:19]
    buffer_load_dwordx4 a[16:19], v103, s[28:31], 0 offen nt
    v_xor_b32 v103, s62, v103
    v_and_b32_dpp v56, v75, v12 row_ror:8 row_mask:0xf bank_mask:0xf
    v_and_b32_dpp v57, v75, v13 row_ror:12 row_mask:0xf bank_mask:0xf
    v_and_b32_dpp v58, v75, v14 quad_perm:[0,1,2,3] row_mask:0xf bank_mask:0xf
    v_and_b32_dpp v59, v75, v15 row_ror:4 row_mask:0xf bank_mask:0xf
    s_waitcnt vmcnt(42)
    v_mfma_f32_16x16x32_bf16 v[16:19], a[20:23], v[52:55], v[16:19]
    buffer_load_dwordx4 a[20:23], v103, s[28:31], 0 offen nt
    v_xor_b32 v103, s65, v103
    v_and_b32_dpp v60, v75, v12 row_ror:4 row_mask:0xf bank_mask:0xf
    v_and_b32_dpp v61, v75, v13 row_ror:8 row_mask:0xf bank_mask:0xf
    v_and_b32_dpp v62, v75, v14 row_ror:12 row_mask:0xf bank_mask:0xf
    v_and_b32_dpp v63, v75, v15 quad_perm:[0,1,2,3] row_mask:0xf bank_mask:0xf
    s_waitcnt vmcnt(42)
    v_mfma_f32_16x16x32_bf16 v[16:19], a[24:27], v[56:59], v[16:19]
    buffer_load_dwordx4 a[24:27], v103, s[28:31], 0 offen nt
    v_xor_b32 v103, s62, v103
    v_and_b32_dpp v52, v76, v12 quad_perm:[0,1,2,3] row_mask:0xf bank_mask:0xf
    v_and_b32_dpp v53, v76, v13 row_ror:4 row_mask:0xf bank_mask:0xf
    v_and_b32_dpp v54, v76, v14 row_ror:8 row_mask:0xf bank_mask:0xf
    v_and_b32_dpp v55, v76, v15 row_ror:12 row_mask:0xf bank_mask:0xf
    s_waitcnt vmcnt(42)
    v_mfma_f32_16x16x32_bf16 v[16:19], a[28:31], v[60:63], v[16:19]
    buffer_load_dwordx4 a[28:31], v103, s[28:31], 0 offen nt
    v_xor_b32 v103, s63, v103
    v_and_b32_dpp v56, v76, v12 row_ror:12 row_mask:0xf bank_mask:0xf
    v_and_b32_dpp v57, v76, v13 quad_perm:[0,1,2,3] row_mask:0xf bank_mask:0xf
    v_and_b32_dpp v58, v76, v14 row_ror:4 row_mask:0xf bank_mask:0xf
    v_and_b32_dpp v59, v76, v15 row_ror:8 row_mask:0xf bank_mask:0xf
    s_waitcnt vmcnt(42)
    v_mfma_f32_16x16x32_bf16 v[16:19], a[32:35], v[52:55], v[16:19]
    buffer_load_dwordx4 a[32:35], v103, s[28:31], 0 offen nt
    v_xor_b32 v103, s62, v103
    v_and_b32_dpp v60, v76, v12 row_ror:8 row_mask:0xf bank_mask:0xf
    v_and_b32_dpp v61, v76, v13 row_ror:12 row_mask:0xf bank_mask:0xf
    v_and_b32_dpp v62, v76, v14 quad_perm:[0,1,2,3] row_mask:0xf bank_mask:0xf
    v_and_b32_dpp v63, v76, v15 row_ror:4 row_mask:0xf bank_mask:0xf
    s_waitcnt vmcnt(42)
    v_mfma_f32_16x16x32_bf16 v[16:19], a[36:39], v[56:59], v[16:19]
    buffer_load_dwordx4 a[36:39], v103, s[28:31], 0 offen nt
    v_xor_b32 v103, s64, v103
    v_and_b32_dpp v52, v76, v12 row_ror:4 row_mask:0xf bank_mask:0xf
    v_and_b32_dpp v53, v76, v13 row_ror:8 row_mask:0xf bank_mask:0xf
    v_and_b32_dpp v54, v76, v14 row_ror:12 row_mask:0xf bank_mask:0xf
    v_and_b32_dpp v55, v76, v15 quad_perm:[0,1,2,3] row_mask:0xf bank_mask:0xf
    s_waitcnt vmcnt(42)
    v_mfma_f32_16x16x32_bf16 v[16:19], a[40:43], v[60:63], v[16:19]
    buffer_load_dwordx4 a[40:43], v103, s[28:31], 0 offen nt
    v_xor_b32 v103, s62, v103
    v_and_b32_dpp v56, v77, v12 quad_perm:[0,1,2,3] row_mask:0xf bank_mask:0xf
    v_and_b32_dpp v57, v77, v13 row_ror:4 row_mask:0xf bank_mask:0xf
    v_and_b32_dpp v58, v77, v14 row_ror:8 row_mask:0xf bank_mask:0xf
    v_and_b32_dpp v59, v77, v15 row_ror:12 row_mask:0xf bank_mask:0xf
    s_waitcnt vmcnt(42)
    v_mfma_f32_16x16x32_bf16 v[16:19], a[44:47], v[52:55], v[16:19]
    buffer_load_dwordx4 a[44:47], v103, s[28:31], 0 offen nt
    v_xor_b32 v103, s63, v103
    v_and_b32_dpp v60, v77, v12 row_ror:12 row_mask:0xf bank_mask:0xf
    v_and_b32_dpp v61, v77, v13 quad_perm:[0,1,2,3] row_mask:0xf bank_mask:0xf
    v_and_b32_dpp v62, v77, v14 row_ror:4 row_mask:0xf bank_mask:0xf
    v_and_b32_dpp v63, v77, v15 row_ror:8 row_mask:0xf bank_mask:0xf
    s_waitcnt vmcnt(42)
    v_mfma_f32_16x16x32_bf16 v[16:19], a[48:51], v[56:59], v[16:19]
    buffer_load_dwordx4 a[48:51], v103, s[28:31], 0 offen nt
    v_xor_b32 v103, s62, v103
    v_and_b32_dpp v52, v77, v12 row_ror:8 row_mask:0xf bank_mask:0xf
    v_and_b32_dpp v53, v77, v13 row_ror:12 row_mask:0xf bank_mask:0xf
    v_and_b32_dpp v54, v77, v14 quad_perm:[0,1,2,3] row_mask:0xf bank_mask:0xf
    v_and_b32_dpp v55, v77, v15 row_ror:4 row_mask:0xf bank_mask:0xf
    s_waitcnt vmcnt(42)
    v_mfma_f32_16x16x32_bf16 v[16:19], a[52:55], v[60:63], v[16:19]
    buffer_load_dwordx4 a[52:55], v103, s[28:31], 0 offen nt
    v_xor_b32 v103, s67, v103
    v_and_b32_dpp v56, v77, v12 row_ror:4 row_mask:0xf bank_mask:0xf
    v_and_b32_dpp v57, v77, v13 row_ror:8 row_mask:0xf bank_mask:0xf
    v_and_b32_dpp v58, v77, v14 row_ror:12 row_mask:0xf bank_mask:0xf
    v_and_b32_dpp v59, v77, v15 quad_perm:[0,1,2,3] row_mask:0xf bank_mask:0xf
    s_waitcnt vmcnt(42)
    v_mfma_f32_16x16x32_bf16 v[16:19], a[56:59], v[52:55], v[16:19]
    buffer_load_dwordx4 a[56:59], v103, s[28:31], 0 offen nt
    v_xor_b32 v103, s62, v103
    v_and_b32_dpp v60, v78, v12 quad_perm:[0,1,2,3] row_mask:0xf bank_mask:0xf
    v_and_b32_dpp v61, v78, v13 row_ror:4 row_mask:0xf bank_mask:0xf
    v_and_b32_dpp v62, v78, v14 row_ror:8 row_mask:0xf bank_mask:0xf
    v_and_b32_dpp v63, v78, v15 row_ror:12 row_mask:0xf bank_mask:0xf
    s_waitcnt vmcnt(42)
    v_mfma_f32_16x16x32_bf16 v[16:19], a[60:63], v[56:59], v[16:19]
    buffer_load_dwordx4 a[60:63], v103, s[28:31], 0 offen nt
    v_xor_b32 v103, s63, v103
    v_and_b32_dpp v52, v78, v12 row_ror:12 row_mask:0xf bank_mask:0xf
    v_and_b32_dpp v53, v78, v13 quad_perm:[0,1,2,3] row_mask:0xf bank_mask:0xf
    v_and_b32_dpp v54, v78, v14 row_ror:4 row_mask:0xf bank_mask:0xf
    v_and_b32_dpp v55, v78, v15 row_ror:8 row_mask:0xf bank_mask:0xf
    s_waitcnt vmcnt(42)
    v_mfma_f32_16x16x32_bf16 v[16:19], a[64:67], v[60:63], v[16:19]
    buffer_load_dwordx4 a[64:67], v103, s[28:31], 0 offen nt
    v_xor_b32 v103, s62, v103
    v_and_b32_dpp v56, v78, v12 row_ror:8 row_mask:0xf bank_mask:0xf
    v_and_b32_dpp v57, v78, v13 row_ror:12 row_mask:0xf bank_mask:0xf
    v_and_b32_dpp v58, v78, v14 quad_perm:[0,1,2,3] row_mask:0xf bank_mask:0xf
    v_and_b32_dpp v59, v78, v15 row_ror:4 row_mask:0xf bank_mask:0xf
    s_waitcnt vmcnt(42)
    v_mfma_f32_16x16x32_bf16 v[16:19], a[68:71], v[52:55], v[16:19]
    buffer_load_dwordx4 a[68:71], v103, s[28:31], 0 offen nt
    v_xor_b32 v103, s64, v103
    v_and_b32_dpp v60, v78, v12 row_ror:4 row_mask:0xf bank_mask:0xf
    v_and_b32_dpp v61, v78, v13 row_ror:8 row_mask:0xf bank_mask:0xf
    v_and_b32_dpp v62, v78, v14 row_ror:12 row_mask:0xf bank_mask:0xf
    v_and_b32_dpp v63, v78, v15 quad_perm:[0,1,2,3] row_mask:0xf bank_mask:0xf
    s_waitcnt vmcnt(42)
    v_mfma_f32_16x16x32_bf16 v[16:19], a[72:75], v[56:59], v[16:19]
    buffer_load_dwordx4 a[72:75], v103, s[28:31], 0 offen nt
    v_xor_b32 v103, s62, v103
    v_and_b32_dpp v52, v79, v12 quad_perm:[0,1,2,3] row_mask:0xf bank_mask:0xf
    v_and_b32_dpp v53, v79, v13 row_ror:4 row_mask:0xf bank_mask:0xf
    v_and_b32_dpp v54, v79, v14 row_ror:8 row_mask:0xf bank_mask:0xf
    v_and_b32_dpp v55, v79, v15 row_ror:12 row_mask:0xf bank_mask:0xf
    s_waitcnt vmcnt(42)
    v_mfma_f32_16x16x32_bf16 v[16:19], a[76:79], v[60:63], v[16:19]
    buffer_load_dwordx4 a[76:79], v103, s[28:31], 0 offen nt
    v_xor_b32 v103, s63, v103
    v_and_b32_dpp v56, v79, v12 row_ror:12 row_mask:0xf bank_mask:0xf
    v_and_b32_dpp v57, v79, v13 quad_perm:[0,1,2,3] row_mask:0xf bank_mask:0xf
    v_and_b32_dpp v58, v79, v14 row_ror:4 row_mask:0xf bank_mask:0xf
    v_and_b32_dpp v59, v79, v15 row_ror:8 row_mask:0xf bank_mask:0xf
    s_waitcnt vmcnt(42)
    v_mfma_f32_16x16x32_bf16 v[16:19], a[80:83], v[52:55], v[16:19]
    buffer_load_dwordx4 a[80:83], v103, s[28:31], 0 offen nt
    v_xor_b32 v103, s62, v103
    v_and_b32_dpp v60, v79, v12 row_ror:8 row_mask:0xf bank_mask:0xf
    v_and_b32_dpp v61, v79, v13 row_ror:12 row_mask:0xf bank_mask:0xf
    v_and_b32_dpp v62, v79, v14 quad_perm:[0,1,2,3] row_mask:0xf bank_mask:0xf
    v_and_b32_dpp v63, v79, v15 row_ror:4 row_mask:0xf bank_mask:0xf
    s_waitcnt vmcnt(42)
    v_mfma_f32_16x16x32_bf16 v[16:19], a[84:87], v[56:59], v[16:19]
    buffer_load_dwordx4 a[84:87], v103, s[28:31], 0 offen nt
    v_xor_b32 v103, s65, v103
    v_and_b32_dpp v52, v79, v12 row_ror:4 row_mask:0xf bank_mask:0xf
    v_and_b32_dpp v53, v79, v13 row_ror:8 row_mask:0xf bank_mask:0xf
    v_and_b32_dpp v54, v79, v14 row_ror:12 row_mask:0xf bank_mask:0xf
    v_and_b32_dpp v55, v79, v15 quad_perm:[0,1,2,3] row_mask:0xf bank_mask:0xf
    s_waitcnt vmcnt(42)
    v_mfma_f32_16x16x32_bf16 v[16:19], a[88:91], v[60:63], v[16:19]
    buffer_load_dwordx4 a[88:91], v103, s[28:31], 0 offen nt
    v_xor_b32 v103, s62, v103
    v_and_b32_dpp v56, v80, v12 quad_perm:[0,1,2,3] row_mask:0xf bank_mask:0xf
    v_and_b32_dpp v57, v80, v13 row_ror:4 row_mask:0xf bank_mask:0xf
    v_and_b32_dpp v58, v80, v14 row_ror:8 row_mask:0xf bank_mask:0xf
    v_and_b32_dpp v59, v80, v15 row_ror:12 row_mask:0xf bank_mask:0xf
    s_waitcnt vmcnt(42)
    v_mfma_f32_16x16x32_bf16 v[16:19], a[92:95], v[52:55], v[16:19]
    buffer_load_dwordx4 a[92:95], v103, s[28:31], 0 offen nt
    v_xor_b32 v103, s63, v103
    v_and_b32_dpp v60, v80, v12 row_ror:12 row_mask:0xf bank_mask:0xf
    v_and_b32_dpp v61, v80, v13 quad_perm:[0,1,2,3] row_mask:0xf bank_mask:0xf
    v_and_b32_dpp v62, v80, v14 row_ror:4 row_mask:0xf bank_mask:0xf
    v_and_b32_dpp v63, v80, v15 row_ror:8 row_mask:0xf bank_mask:0xf
    s_waitcnt vmcnt(42)
    v_mfma_f32_16x16x32_bf16 v[16:19], a[96:99], v[56:59], v[16:19]
    buffer_load_dwordx4 a[96:99], v103, s[28:31], 0 offen nt
    v_xor_b32 v103, s62, v103
    v_and_b32_dpp v52, v80, v12 row_ror:8 row_mask:0xf bank_mask:0xf
    v_and_b32_dpp v53, v80, v13 row_ror:12 row_mask:0xf bank_mask:0xf
    v_and_b32_dpp v54, v80, v14 quad_perm:[0,1,2,3] row_mask:0xf bank_mask:0xf
    v_and_b32_dpp v55, v80, v15 row_ror:4 row_mask:0xf bank_mask:0xf
    s_waitcnt vmcnt(42)
    v_mfma_f32_16x16x32_bf16 v[16:19], a[100:103], v[60:63], v[16:19]
    buffer_load_dwordx4 a[100:103], v103, s[28:31], 0 offen nt
    v_xor_b32 v103, s64, v103
    v_and_b32_dpp v56, v80, v12 row_ror:4 row_mask:0xf bank_mask:0xf
    v_and_b32_dpp v57, v80, v13 row_ror:8 row_mask:0xf bank_mask:0xf
    v_and_b32_dpp v58, v80, v14 row_ror:12 row_mask:0xf bank_mask:0xf
    v_and_b32_dpp v59, v80, v15 quad_perm:[0,1,2,3] row_mask:0xf bank_mask:0xf
    s_waitcnt vmcnt(42)
    v_mfma_f32_16x16x32_bf16 v[16:19], a[104:107], v[52:55], v[16:19]
    buffer_load_dwordx4 a[104:107], v103, s[28:31], 0 offen nt
    v_xor_b32 v103, s62, v103
    buffer_load_dwordx2 v[100:101], v6, s[48:51], s15 offen sc1
    v_and_b32_dpp v60, v81, v12 quad_perm:[0,1,2,3] row_mask:0xf bank_mask:0xf
    v_and_b32_dpp v61, v81, v13 row_ror:4 row_mask:0xf bank_mask:0xf
    v_and_b32_dpp v62, v81, v14 row_ror:8 row_mask:0xf bank_mask:0xf
    v_and_b32_dpp v63, v81, v15 row_ror:12 row_mask:0xf bank_mask:0xf
    s_waitcnt vmcnt(43)
    v_mfma_f32_16x16x32_bf16 v[16:19], a[108:111], v[56:59], v[16:19]
    buffer_load_dwordx4 a[108:111], v103, s[28:31], 0 offen nt
    v_xor_b32 v103, s63, v103
    v_and_b32_dpp v52, v81, v12 row_ror:12 row_mask:0xf bank_mask:0xf
    v_and_b32_dpp v53, v81, v13 quad_perm:[0,1,2,3] row_mask:0xf bank_mask:0xf
    v_and_b32_dpp v54, v81, v14 row_ror:4 row_mask:0xf bank_mask:0xf
    v_and_b32_dpp v55, v81, v15 row_ror:8 row_mask:0xf bank_mask:0xf
    s_waitcnt vmcnt(43)
    v_mfma_f32_16x16x32_bf16 v[16:19], a[112:115], v[60:63], v[16:19]
    buffer_load_dwordx4 a[112:115], v103, s[28:31], 0 offen nt
    v_xor_b32 v103, s62, v103
    v_and_b32_dpp v56, v81, v12 row_ror:8 row_mask:0xf bank_mask:0xf
    v_and_b32_dpp v57, v81, v13 row_ror:12 row_mask:0xf bank_mask:0xf
    v_and_b32_dpp v58, v81, v14 quad_perm:[0,1,2,3] row_mask:0xf bank_mask:0xf
    v_and_b32_dpp v59, v81, v15 row_ror:4 row_mask:0xf bank_mask:0xf
    s_waitcnt vmcnt(43)
    v_mfma_f32_16x16x32_bf16 v[16:19], a[116:119], v[52:55], v[16:19]
    buffer_load_dwordx4 a[116:119], v103, s[28:31], 0 offen nt
    v_xor_b32 v103, s66, v103
    v_and_b32_dpp v60, v81, v12 row_ror:4 row_mask:0xf bank_mask:0xf
    v_and_b32_dpp v61, v81, v13 row_ror:8 row_mask:0xf bank_mask:0xf
    v_and_b32_dpp v62, v81, v14 row_ror:12 row_mask:0xf bank_mask:0xf
    v_and_b32_dpp v63, v81, v15 quad_perm:[0,1,2,3] row_mask:0xf bank_mask:0xf
    s_waitcnt vmcnt(43)
    v_mfma_f32_16x16x32_bf16 v[16:19], a[120:123], v[56:59], v[16:19]
    buffer_load_dwordx4 a[120:123], v103, s[28:31], 0 offen nt
    v_xor_b32 v103, s62, v103
    v_and_b32_dpp v52, v82, v12 quad_perm:[0,1,2,3] row_mask:0xf bank_mask:0xf
    v_and_b32_dpp v53, v82, v13 row_ror:4 row_mask:0xf bank_mask:0xf
    v_and_b32_dpp v54, v82, v14 row_ror:8 row_mask:0xf bank_mask:0xf
    v_and_b32_dpp v55, v82, v15 row_ror:12 row_mask:0xf bank_mask:0xf
    s_waitcnt vmcnt(43)
    v_mfma_f32_16x16x32_bf16 v[16:19], a[124:127], v[60:63], v[16:19]
    buffer_load_dwordx4 a[124:127], v103, s[28:31], 0 offen nt
    v_xor_b32 v103, s63, v103
    v_and_b32_dpp v56, v82, v12 row_ror:12 row_mask:0xf bank_mask:0xf
    v_and_b32_dpp v57, v82, v13 quad_perm:[0,1,2,3] row_mask:0xf bank_mask:0xf
    v_and_b32_dpp v58, v82, v14 row_ror:4 row_mask:0xf bank_mask:0xf
    v_and_b32_dpp v59, v82, v15 row_ror:8 row_mask:0xf bank_mask:0xf
    v_and_b32_dpp v104, v89, v12 quad_perm:[0,1,2,3] row_mask:0xf bank_mask:0xf
    v_and_b32_dpp v105, v89, v13 row_ror:4 row_mask:0xf bank_mask:0xf
    v_and_b32_dpp v106, v89, v14 row_ror:8 row_mask:0xf bank_mask:0xf
    v_and_b32_dpp v107, v89, v15 row_ror:12 row_mask:0xf bank_mask:0xf
    s_waitcnt vmcnt(43)
    v_mfma_f32_16x16x32_bf16 v[16:19], a[128:131], v[52:55], v[16:19]
    buffer_load_dwordx4 a[128:131], v103, s[28:31], 0 offen nt
    v_xor_b32 v103, s62, v103
    v_and_b32_dpp v60, v82, v12 row_ror:8 row_mask:0xf bank_mask:0xf
    v_and_b32_dpp v61, v82, v13 row_ror:12 row_mask:0xf bank_mask:0xf
    v_and_b32_dpp v62, v82, v14 quad_perm:[0,1,2,3] row_mask:0xf bank_mask:0xf
    v_and_b32_dpp v63, v82, v15 row_ror:4 row_mask:0xf bank_mask:0xf
    v_and_b32_dpp v108, v89, v12 row_ror:12 row_mask:0xf bank_mask:0xf
    v_and_b32_dpp v109, v89, v13 quad_perm:[0,1,2,3] row_mask:0xf bank_mask:0xf
    v_and_b32_dpp v110, v89, v14 row_ror:4 row_mask:0xf bank_mask:0xf
    v_and_b32_dpp v111, v89, v15 row_ror:8 row_mask:0xf bank_mask:0xf
    s_waitcnt vmcnt(43)
    v_mfma_f32_16x16x32_bf16 v[16:19], a[132:135], v[56:59], v[16:19]
    buffer_load_dwordx4 a[132:135], v103, s[28:31], 0 offen nt
    v_xor_b32 v103, s64, v103
    v_and_b32_dpp v52, v82, v12 row_ror:4 row_mask:0xf bank_mask:0xf
    v_and_b32_dpp v53, v82, v13 row_ror:8 row_mask:0xf bank_mask:0xf
    v_and_b32_dpp v54, v82, v14 row_ror:12 row_mask:0xf bank_mask:0xf
    v_and_b32_dpp v55, v82, v15 quad_perm:[0,1,2,3] row_mask:0xf bank_mask:0xf
    v_and_b32_dpp v112, v89, v12 row_ror:8 row_mask:0xf bank_mask:0xf
    v_and_b32_dpp v113, v89, v13 row_ror:12 row_mask:0xf bank_mask:0xf
    v_and_b32_dpp v114, v89, v14 quad_perm:[0,1,2,3] row_mask:0xf bank_mask:0xf
    v_and_b32_dpp v115, v89, v15 row_ror:4 row_mask:0xf bank_mask:0xf
    s_waitcnt vmcnt(42)
    v_mfma_f32_16x16x32_bf16 v[16:19], a[136:139], v[60:63], v[16:19]
    buffer_load_dwordx4 a[136:139], v103, s[28:31], 0 offen nt
    v_xor_b32 v103, s62, v103
    v_and_b32_dpp v56, v83, v12 quad_perm:[0,1,2,3] row_mask:0xf bank_mask:0xf
    v_and_b32_dpp v57, v83, v13 row_ror:4 row_mask:0xf bank_mask:0xf
    v_and_b32_dpp v58, v83, v14 row_ror:8 row_mask:0xf bank_mask:0xf
    v_and_b32_dpp v59, v83, v15 row_ror:12 row_mask:0xf bank_mask:0xf
    v_and_b32_dpp v116, v89, v12 row_ror:4 row_mask:0xf bank_mask:0xf
    v_and_b32_dpp v117, v89, v13 row_ror:8 row_mask:0xf bank_mask:0xf
    v_and_b32_dpp v118, v89, v14 row_ror:12 row_mask:0xf bank_mask:0xf
    v_and_b32_dpp v119, v89, v15 quad_perm:[0,1,2,3] row_mask:0xf bank_mask:0xf
    s_waitcnt vmcnt(42)
    v_mfma_f32_16x16x32_bf16 v[16:19], a[140:143], v[52:55], v[16:19]
    buffer_load_dwordx4 a[140:143], v103, s[28:31], 0 offen nt
    v_xor_b32 v103, s63, v103
    v_and_b32_dpp v60, v83, v12 row_ror:12 row_mask:0xf bank_mask:0xf
    v_and_b32_dpp v61, v83, v13 quad_perm:[0,1,2,3] row_mask:0xf bank_mask:0xf
    v_and_b32_dpp v62, v83, v14 row_ror:4 row_mask:0xf bank_mask:0xf
    v_and_b32_dpp v63, v83, v15 row_ror:8 row_mask:0xf bank_mask:0xf
    v_and_b32_dpp v120, v90, v12 quad_perm:[0,1,2,3] row_mask:0xf bank_mask:0xf
    v_and_b32_dpp v121, v90, v13 row_ror:4 row_mask:0xf bank_mask:0xf
    v_and_b32_dpp v122, v90, v14 row_ror:8 row_mask:0xf bank_mask:0xf
    v_and_b32_dpp v123, v90, v15 row_ror:12 row_mask:0xf bank_mask:0xf
    s_waitcnt vmcnt(42)
    v_mfma_f32_16x16x32_bf16 v[16:19], a[144:147], v[56:59], v[16:19]
    buffer_load_dwordx4 a[144:147], v103, s[28:31], 0 offen nt
    v_xor_b32 v103, s62, v103
    v_and_b32_dpp v52, v83, v12 row_ror:8 row_mask:0xf bank_mask:0xf
    v_and_b32_dpp v53, v83, v13 row_ror:12 row_mask:0xf bank_mask:0xf
    v_and_b32_dpp v54, v83, v14 quad_perm:[0,1,2,3] row_mask:0xf bank_mask:0xf
    v_and_b32_dpp v55, v83, v15 row_ror:4 row_mask:0xf bank_mask:0xf
    v_and_b32_dpp v124, v90, v12 row_ror:12 row_mask:0xf bank_mask:0xf
    v_and_b32_dpp v125, v90, v13 quad_perm:[0,1,2,3] row_mask:0xf bank_mask:0xf
    v_and_b32_dpp v126, v90, v14 row_ror:4 row_mask:0xf bank_mask:0xf
    v_and_b32_dpp v127, v90, v15 row_ror:8 row_mask:0xf bank_mask:0xf
    s_waitcnt vmcnt(42)
    v_mfma_f32_16x16x32_bf16 v[16:19], a[148:151], v[60:63], v[16:19]
    buffer_load_dwordx4 a[148:151], v103, s[28:31], 0 offen nt
    v_xor_b32 v103, s65, v103
    v_and_b32_dpp v56, v83, v12 row_ror:4 row_mask:0xf bank_mask:0xf
    v_and_b32_dpp v57, v83, v13 row_ror:8 row_mask:0xf bank_mask:0xf
    v_and_b32_dpp v58, v83, v14 row_ror:12 row_mask:0xf bank_mask:0xf
    v_and_b32_dpp v59, v83, v15 quad_perm:[0,1,2,3] row_mask:0xf bank_mask:0xf
    v_and_b32_dpp v128, v90, v12 row_ror:8 row_mask:0xf bank_mask:0xf
    v_and_b32_dpp v129, v90, v13 row_ror:12 row_mask:0xf bank_mask:0xf
    v_and_b32_dpp v130, v90, v14 quad_perm:[0,1,2,3] row_mask:0xf bank_mask:0xf
    v_and_b32_dpp v131, v90, v15 row_ror:4 row_mask:0xf bank_mask:0xf
    s_waitcnt vmcnt(42)
    v_mfma_f32_16x16x32_bf16 v[16:19], a[152:155], v[52:55], v[16:19]
    buffer_load_dwordx4 a[152:155], v103, s[28:31], 0 offen nt
    v_xor_b32 v103, s62, v103
    v_and_b32_dpp v60, v84, v12 quad_perm:[0,1,2,3] row_mask:0xf bank_mask:0xf
    v_and_b32_dpp v61, v84, v13 row_ror:4 row_mask:0xf bank_mask:0xf
    v_and_b32_dpp v62, v84, v14 row_ror:8 row_mask:0xf bank_mask:0xf
    v_and_b32_dpp v63, v84, v15 row_ror:12 row_mask:0xf bank_mask:0xf
    v_and_b32_dpp v132, v90, v12 row_ror:4 row_mask:0xf bank_mask:0xf
    v_and_b32_dpp v133, v90, v13 row_ror:8 row_mask:0xf bank_mask:0xf
    v_and_b32_dpp v134, v90, v14 row_ror:12 row_mask:0xf bank_mask:0xf
    v_and_b32_dpp v135, v90, v15 quad_perm:[0,1,2,3] row_mask:0xf bank_mask:0xf
    s_waitcnt vmcnt(42)
    v_mfma_f32_16x16x32_bf16 v[16:19], a[156:159], v[56:59], v[16:19]
    buffer_load_dwordx4 a[156:159], v103, s[28:31], 0 offen nt
    v_xor_b32 v103, s63, v103
    v_and_b32_dpp v52, v84, v12 row_ror:12 row_mask:0xf bank_mask:0xf
    v_and_b32_dpp v53, v84, v13 quad_perm:[0,1,2,3] row_mask:0xf bank_mask:0xf
    v_and_b32_dpp v54, v84, v14 row_ror:4 row_mask:0xf bank_mask:0xf
    v_and_b32_dpp v55, v84, v15 row_ror:8 row_mask:0xf bank_mask:0xf
    v_and_b32_dpp v136, v91, v12 quad_perm:[0,1,2,3] row_mask:0xf bank_mask:0xf
    v_and_b32_dpp v137, v91, v13 row_ror:4 row_mask:0xf bank_mask:0xf
    v_and_b32_dpp v138, v91, v14 row_ror:8 row_mask:0xf bank_mask:0xf
    v_and_b32_dpp v139, v91, v15 row_ror:12 row_mask:0xf bank_mask:0xf
    s_waitcnt vmcnt(42)
    v_mfma_f32_16x16x32_bf16 v[16:19], a[160:163], v[60:63], v[16:19]
    buffer_load_dwordx4 a[160:163], v103, s[28:31], 0 offen nt
    v_xor_b32 v103, s62, v103
    v_and_b32_dpp v56, v84, v12 row_ror:8 row_mask:0xf bank_mask:0xf
    v_and_b32_dpp v57, v84, v13 row_ror:12 row_mask:0xf bank_mask:0xf
    v_and_b32_dpp v58, v84, v14 quad_perm:[0,1,2,3] row_mask:0xf bank_mask:0xf
    v_and_b32_dpp v59, v84, v15 row_ror:4 row_mask:0xf bank_mask:0xf
    v_and_b32_dpp v140, v91, v12 row_ror:12 row_mask:0xf bank_mask:0xf
    v_and_b32_dpp v141, v91, v13 quad_perm:[0,1,2,3] row_mask:0xf bank_mask:0xf
    v_and_b32_dpp v142, v91, v14 row_ror:4 row_mask:0xf bank_mask:0xf
    v_and_b32_dpp v143, v91, v15 row_ror:8 row_mask:0xf bank_mask:0xf
    s_waitcnt vmcnt(42)
    v_mfma_f32_16x16x32_bf16 v[16:19], a[164:167], v[52:55], v[16:19]
    buffer_load_dwordx4 a[164:167], v103, s[28:31], 0 offen nt
    v_xor_b32 v103, s64, v103
    v_and_b32_dpp v60, v84, v12 row_ror:4 row_mask:0xf bank_mask:0xf
    v_and_b32_dpp v61, v84, v13 row_ror:8 row_mask:0xf bank_mask:0xf
    v_and_b32_dpp v62, v84, v14 row_ror:12 row_mask:0xf bank_mask:0xf
    v_and_b32_dpp v63, v84, v15 quad_perm:[0,1,2,3] row_mask:0xf bank_mask:0xf
    v_and_b32_dpp v144, v91, v12 row_ror:8 row_mask:0xf bank_mask:0xf
    v_and_b32_dpp v145, v91, v13 row_ror:12 row_mask:0xf bank_mask:0xf
    v_and_b32_dpp v146, v91, v14 quad_perm:[0,1,2,3] row_mask:0xf bank_mask:0xf
    v_and_b32_dpp v147, v91, v15 row_ror:4 row_mask:0xf bank_mask:0xf
    s_waitcnt vmcnt(42)
    v_mfma_f32_16x16x32_bf16 v[16:19], a[0:3], v[56:59], v[16:19]
    buffer_load_dwordx4 a[0:3], v103, s[28:31], 0 offen nt
    v_xor_b32 v103, s62, v103
    v_and_b32_dpp v52, v85, v12 quad_perm:[0,1,2,3] row_mask:0xf bank_mask:0xf
    v_and_b32_dpp v53, v85, v13 row_ror:4 row_mask:0xf bank_mask:0xf
    v_and_b32_dpp v54, v85, v14 row_ror:8 row_mask:0xf bank_mask:0xf
    v_and_b32_dpp v55, v85, v15 row_ror:12 row_mask:0xf bank_mask:0xf
    v_and_b32_dpp v148, v91, v12 row_ror:4 row_mask:0xf bank_mask:0xf
    v_and_b32_dpp v149, v91, v13 row_ror:8 row_mask:0xf bank_mask:0xf
    v_and_b32_dpp v150, v91, v14 row_ror:12 row_mask:0xf bank_mask:0xf
    v_and_b32_dpp v151, v91, v15 quad_perm:[0,1,2,3] row_mask:0xf bank_mask:0xf
    s_waitcnt vmcnt(42)
    v_mfma_f32_16x16x32_bf16 v[16:19], a[4:7], v[60:63], v[16:19]
    buffer_load_dwordx4 a[4:7], v103, s[28:31], 0 offen nt
    v_xor_b32 v103, s63, v103
    v_and_b32_dpp v56, v85, v12 row_ror:12 row_mask:0xf bank_mask:0xf
    v_and_b32_dpp v57, v85, v13 quad_perm:[0,1,2,3] row_mask:0xf bank_mask:0xf
    v_and_b32_dpp v58, v85, v14 row_ror:4 row_mask:0xf bank_mask:0xf
    v_and_b32_dpp v59, v85, v15 row_ror:8 row_mask:0xf bank_mask:0xf
    v_and_b32_dpp v152, v92, v12 quad_perm:[0,1,2,3] row_mask:0xf bank_mask:0xf
    v_and_b32_dpp v153, v92, v13 row_ror:4 row_mask:0xf bank_mask:0xf
    v_and_b32_dpp v154, v92, v14 row_ror:8 row_mask:0xf bank_mask:0xf
    v_and_b32_dpp v155, v92, v15 row_ror:12 row_mask:0xf bank_mask:0xf
    s_waitcnt vmcnt(42)
    v_mfma_f32_16x16x32_bf16 v[16:19], a[8:11], v[52:55], v[16:19]
    buffer_load_dwordx4 a[8:11], v103, s[28:31], 0 offen nt
    v_xor_b32 v103, s62, v103
    v_and_b32_dpp v60, v85, v12 row_ror:8 row_mask:0xf bank_mask:0xf
    v_and_b32_dpp v61, v85, v13 row_ror:12 row_mask:0xf bank_mask:0xf
    v_and_b32_dpp v62, v85, v14 quad_perm:[0,1,2,3] row_mask:0xf bank_mask:0xf
    v_and_b32_dpp v63, v85, v15 row_ror:4 row_mask:0xf bank_mask:0xf
    v_and_b32_dpp v156, v92, v12 row_ror:12 row_mask:0xf bank_mask:0xf
    v_and_b32_dpp v157, v92, v13 quad_perm:[0,1,2,3] row_mask:0xf bank_mask:0xf
    v_and_b32_dpp v158, v92, v14 row_ror:4 row_mask:0xf bank_mask:0xf
    v_and_b32_dpp v159, v92, v15 row_ror:8 row_mask:0xf bank_mask:0xf
    s_waitcnt vmcnt(42)
    v_mfma_f32_16x16x32_bf16 v[16:19], a[12:15], v[56:59], v[16:19]
    buffer_load_dwordx4 a[12:15], v103, s[28:31], 0 offen nt
    v_and_b32_dpp v52, v85, v12 row_ror:4 row_mask:0xf bank_mask:0xf
    v_and_b32_dpp v53, v85, v13 row_ror:8 row_mask:0xf bank_mask:0xf
    v_and_b32_dpp v54, v85, v14 row_ror:12 row_mask:0xf bank_mask:0xf
    v_and_b32_dpp v55, v85, v15 quad_perm:[0,1,2,3] row_mask:0xf bank_mask:0xf
    v_and_b32_dpp v160, v92, v12 row_ror:8 row_mask:0xf bank_mask:0xf
    v_and_b32_dpp v161, v92, v13 row_ror:12 row_mask:0xf bank_mask:0xf
    v_and_b32_dpp v162, v92, v14 quad_perm:[0,1,2,3] row_mask:0xf bank_mask:0xf
    v_and_b32_dpp v163, v92, v15 row_ror:4 row_mask:0xf bank_mask:0xf
    s_waitcnt vmcnt(42)
    v_mfma_f32_16x16x32_bf16 v[16:19], a[16:19], v[60:63], v[16:19]
    v_and_b32_dpp v56, v86, v12 quad_perm:[0,1,2,3] row_mask:0xf bank_mask:0xf
    v_and_b32_dpp v57, v86, v13 row_ror:4 row_mask:0xf bank_mask:0xf
    v_and_b32_dpp v58, v86, v14 row_ror:8 row_mask:0xf bank_mask:0xf
    v_and_b32_dpp v59, v86, v15 row_ror:12 row_mask:0xf bank_mask:0xf
    v_and_b32_dpp v164, v92, v12 row_ror:4 row_mask:0xf bank_mask:0xf
    v_and_b32_dpp v165, v92, v13 row_ror:8 row_mask:0xf bank_mask:0xf
    v_and_b32_dpp v166, v92, v14 row_ror:12 row_mask:0xf bank_mask:0xf
    v_and_b32_dpp v167, v92, v15 quad_perm:[0,1,2,3] row_mask:0xf bank_mask:0xf
    s_waitcnt vmcnt(41)
    v_mfma_f32_16x16x32_bf16 v[16:19], a[20:23], v[52:55], v[16:19]
    v_and_b32_dpp v60, v86, v12 row_ror:12 row_mask:0xf bank_mask:0xf
    v_and_b32_dpp v61, v86, v13 quad_perm:[0,1,2,3] row_mask:0xf bank_mask:0xf
    v_and_b32_dpp v62, v86, v14 row_ror:4 row_mask:0xf bank_mask:0xf
    v_and_b32_dpp v63, v86, v15 row_ror:8 row_mask:0xf bank_mask:0xf
    v_and_b32_dpp v168, v93, v12 quad_perm:[0,1,2,3] row_mask:0xf bank_mask:0xf
    v_and_b32_dpp v169, v93, v13 row_ror:4 row_mask:0xf bank_mask:0xf
    v_and_b32_dpp v170, v93, v14 row_ror:8 row_mask:0xf bank_mask:0xf
    v_and_b32_dpp v171, v93, v15 row_ror:12 row_mask:0xf bank_mask:0xf
    s_waitcnt vmcnt(40)
    v_mfma_f32_16x16x32_bf16 v[16:19], a[24:27], v[56:59], v[16:19]
    v_and_b32_dpp v52, v86, v12 row_ror:8 row_mask:0xf bank_mask:0xf
    v_and_b32_dpp v53, v86, v13 row_ror:12 row_mask:0xf bank_mask:0xf
    v_and_b32_dpp v54, v86, v14 quad_perm:[0,1,2,3] row_mask:0xf bank_mask:0xf
    v_and_b32_dpp v55, v86, v15 row_ror:4 row_mask:0xf bank_mask:0xf
    v_and_b32_dpp v172, v93, v12 row_ror:12 row_mask:0xf bank_mask:0xf
    v_and_b32_dpp v173, v93, v13 quad_perm:[0,1,2,3] row_mask:0xf bank_mask:0xf
    v_and_b32_dpp v174, v93, v14 row_ror:4 row_mask:0xf bank_mask:0xf
    v_and_b32_dpp v175, v93, v15 row_ror:8 row_mask:0xf bank_mask:0xf
    s_waitcnt vmcnt(39)
    v_mfma_f32_16x16x32_bf16 v[16:19], a[28:31], v[60:63], v[16:19]
    v_and_b32_dpp v56, v86, v12 row_ror:4 row_mask:0xf bank_mask:0xf
    v_and_b32_dpp v57, v86, v13 row_ror:8 row_mask:0xf bank_mask:0xf
    v_and_b32_dpp v58, v86, v14 row_ror:12 row_mask:0xf bank_mask:0xf
    v_and_b32_dpp v59, v86, v15 quad_perm:[0,1,2,3] row_mask:0xf bank_mask:0xf
    v_and_b32_dpp v176, v93, v12 row_ror:8 row_mask:0xf bank_mask:0xf
    v_and_b32_dpp v177, v93, v13 row_ror:12 row_mask:0xf bank_mask:0xf
    v_and_b32_dpp v178, v93, v14 quad_perm:[0,1,2,3] row_mask:0xf bank_mask:0xf
    v_and_b32_dpp v179, v93, v15 row_ror:4 row_mask:0xf bank_mask:0xf
    s_waitcnt vmcnt(38)
    v_mfma_f32_16x16x32_bf16 v[16:19], a[32:35], v[52:55], v[16:19]
    v_and_b32_dpp v60, v87, v12 quad_perm:[0,1,2,3] row_mask:0xf bank_mask:0xf
    v_and_b32_dpp v61, v87, v13 row_ror:4 row_mask:0xf bank_mask:0xf
    v_and_b32_dpp v62, v87, v14 row_ror:8 row_mask:0xf bank_mask:0xf
    v_and_b32_dpp v63, v87, v15 row_ror:12 row_mask:0xf bank_mask:0xf
    v_and_b32_dpp v180, v93, v12 row_ror:4 row_mask:0xf bank_mask:0xf
    v_and_b32_dpp v181, v93, v13 row_ror:8 row_mask:0xf bank_mask:0xf
    v_and_b32_dpp v182, v93, v14 row_ror:12 row_mask:0xf bank_mask:0xf
    v_and_b32_dpp v183, v93, v15 quad_perm:[0,1,2,3] row_mask:0xf bank_mask:0xf
    s_waitcnt vmcnt(37)
    v_mfma_f32_16x16x32_bf16 v[16:19], a[36:39], v[56:59], v[16:19]
    v_and_b32_dpp v52, v87, v12 row_ror:12 row_mask:0xf bank_mask:0xf
    v_and_b32_dpp v53, v87, v13 quad_perm:[0,1,2,3] row_mask:0xf bank_mask:0xf
    v_and_b32_dpp v54, v87, v14 row_ror:4 row_mask:0xf bank_mask:0xf
    v_and_b32_dpp v55, v87, v15 row_ror:8 row_mask:0xf bank_mask:0xf
    v_and_b32_dpp v184, v94, v12 quad_perm:[0,1,2,3] row_mask:0xf bank_mask:0xf
    v_and_b32_dpp v185, v94, v13 row_ror:4 row_mask:0xf bank_mask:0xf
    v_and_b32_dpp v186, v94, v14 row_ror:8 row_mask:0xf bank_mask:0xf
    v_and_b32_dpp v187, v94, v15 row_ror:12 row_mask:0xf bank_mask:0xf
    s_waitcnt vmcnt(36)
    v_mfma_f32_16x16x32_bf16 v[16:19], a[40:43], v[60:63], v[16:19]
    s_mov_b64 exec, 0xff
    v_lshlrev_b32 v99, 7, v0
    buffer_load_dword v99, v99, s[48:51], s13 offen sc1
    s_mov_b64 exec, -1
    v_and_b32_dpp v56, v87, v12 row_ror:8 row_mask:0xf bank_mask:0xf
    v_and_b32_dpp v57, v87, v13 row_ror:12 row_mask:0xf bank_mask:0xf
    v_and_b32_dpp v58, v87, v14 quad_perm:[0,1,2,3] row_mask:0xf bank_mask:0xf
    v_and_b32_dpp v59, v87, v15 row_ror:4 row_mask:0xf bank_mask:0xf
    v_and_b32_dpp v188, v94, v12 row_ror:12 row_mask:0xf bank_mask:0xf
    v_and_b32_dpp v189, v94, v13 quad_perm:[0,1,2,3] row_mask:0xf bank_mask:0xf
    v_and_b32_dpp v190, v94, v14 row_ror:4 row_mask:0xf bank_mask:0xf
    v_and_b32_dpp v191, v94, v15 row_ror:8 row_mask:0xf bank_mask:0xf
    s_waitcnt vmcnt(36)
    v_mfma_f32_16x16x32_bf16 v[16:19], a[44:47], v[52:55], v[16:19]
    v_and_b32_dpp v60, v87, v12 row_ror:4 row_mask:0xf bank_mask:0xf
    v_and_b32_dpp v61, v87, v13 row_ror:8 row_mask:0xf bank_mask:0xf
    v_and_b32_dpp v62, v87, v14 row_ror:12 row_mask:0xf bank_mask:0xf
    v_and_b32_dpp v63, v87, v15 quad_perm:[0,1,2,3] row_mask:0xf bank_mask:0xf
    v_and_b32_dpp v192, v94, v12 row_ror:8 row_mask:0xf bank_mask:0xf
    v_and_b32_dpp v193, v94, v13 row_ror:12 row_mask:0xf bank_mask:0xf
    v_and_b32_dpp v194, v94, v14 quad_perm:[0,1,2,3] row_mask:0xf bank_mask:0xf
    v_and_b32_dpp v195, v94, v15 row_ror:4 row_mask:0xf bank_mask:0xf
    s_waitcnt vmcnt(35)
    v_mfma_f32_16x16x32_bf16 v[16:19], a[48:51], v[56:59], v[16:19]
    v_and_b32_dpp v52, v88, v12 quad_perm:[0,1,2,3] row_mask:0xf bank_mask:0xf
    v_and_b32_dpp v53, v88, v13 row_ror:4 row_mask:0xf bank_mask:0xf
    v_and_b32_dpp v54, v88, v14 row_ror:8 row_mask:0xf bank_mask:0xf
    v_and_b32_dpp v55, v88, v15 row_ror:12 row_mask:0xf bank_mask:0xf
    v_and_b32_dpp v196, v94, v12 row_ror:4 row_mask:0xf bank_mask:0xf
    v_and_b32_dpp v197, v94, v13 row_ror:8 row_mask:0xf bank_mask:0xf
    v_and_b32_dpp v198, v94, v14 row_ror:12 row_mask:0xf bank_mask:0xf
    v_and_b32_dpp v199, v94, v15 quad_perm:[0,1,2,3] row_mask:0xf bank_mask:0xf
    s_waitcnt vmcnt(34)
    v_mfma_f32_16x16x32_bf16 v[16:19], a[52:55], v[60:63], v[16:19]
    v_and_b32_dpp v56, v88, v12 row_ror:12 row_mask:0xf bank_mask:0xf
    v_and_b32_dpp v57, v88, v13 quad_perm:[0,1,2,3] row_mask:0xf bank_mask:0xf
    v_and_b32_dpp v58, v88, v14 row_ror:4 row_mask:0xf bank_mask:0xf
    v_and_b32_dpp v59, v88, v15 row_ror:8 row_mask:0xf bank_mask:0xf
    v_and_b32_dpp v200, v95, v12 quad_perm:[0,1,2,3] row_mask:0xf bank_mask:0xf
    v_and_b32_dpp v201, v95, v13 row_ror:4 row_mask:0xf bank_mask:0xf
    v_and_b32_dpp v202, v95, v14 row_ror:8 row_mask:0xf bank_mask:0xf
    v_and_b32_dpp v203, v95, v15 row_ror:12 row_mask:0xf bank_mask:0xf
    s_waitcnt vmcnt(33)
    v_mfma_f32_16x16x32_bf16 v[16:19], a[56:59], v[52:55], v[16:19]
    v_and_b32_dpp v60, v88, v12 row_ror:8 row_mask:0xf bank_mask:0xf
    v_and_b32_dpp v61, v88, v13 row_ror:12 row_mask:0xf bank_mask:0xf
    v_and_b32_dpp v62, v88, v14 quad_perm:[0,1,2,3] row_mask:0xf bank_mask:0xf
    v_and_b32_dpp v63, v88, v15 row_ror:4 row_mask:0xf bank_mask:0xf
    v_and_b32_dpp v204, v95, v12 row_ror:12 row_mask:0xf bank_mask:0xf
    v_and_b32_dpp v205, v95, v13 quad_perm:[0,1,2,3] row_mask:0xf bank_mask:0xf
    v_and_b32_dpp v206, v95, v14 row_ror:4 row_mask:0xf bank_mask:0xf
    v_and_b32_dpp v207, v95, v15 row_ror:8 row_mask:0xf bank_mask:0xf
    s_waitcnt vmcnt(32)
    v_mfma_f32_16x16x32_bf16 v[16:19], a[60:63], v[56:59], v[16:19]
    v_and_b32_dpp v52, v88, v12 row_ror:4 row_mask:0xf bank_mask:0xf
    v_and_b32_dpp v53, v88, v13 row_ror:8 row_mask:0xf bank_mask:0xf
    v_and_b32_dpp v54, v88, v14 row_ror:12 row_mask:0xf bank_mask:0xf
    v_and_b32_dpp v55, v88, v15 quad_perm:[0,1,2,3] row_mask:0xf bank_mask:0xf
    v_and_b32_dpp v208, v95, v12 row_ror:8 row_mask:0xf bank_mask:0xf
    v_and_b32_dpp v209, v95, v13 row_ror:12 row_mask:0xf bank_mask:0xf
    v_and_b32_dpp v210, v95, v14 quad_perm:[0,1,2,3] row_mask:0xf bank_mask:0xf
    v_and_b32_dpp v211, v95, v15 row_ror:4 row_mask:0xf bank_mask:0xf
    s_waitcnt vmcnt(31)
    v_mfma_f32_16x16x32_bf16 v[16:19], a[64:67], v[60:63], v[16:19]
    v_and_b32_dpp v212, v95, v12 row_ror:4 row_mask:0xf bank_mask:0xf
    v_and_b32_dpp v213, v95, v13 row_ror:8 row_mask:0xf bank_mask:0xf
    v_and_b32_dpp v214, v95, v14 row_ror:12 row_mask:0xf bank_mask:0xf
    v_and_b32_dpp v215, v95, v15 quad_perm:[0,1,2,3] row_mask:0xf bank_mask:0xf
    s_waitcnt vmcnt(30)
    v_mfma_f32_16x16x32_bf16 v[16:19], a[68:71], v[52:55], v[16:19]
    s_waitcnt vmcnt(29)
    v_mfma_f32_16x16x32_bf16 v[16:19], a[72:75], v[104:107], v[16:19]
    s_waitcnt vmcnt(28)
    v_mfma_f32_16x16x32_bf16 v[16:19], a[76:79], v[108:111], v[16:19]
    s_waitcnt vmcnt(27)
    v_mfma_f32_16x16x32_bf16 v[16:19], a[80:83], v[112:115], v[16:19]
    s_waitcnt vmcnt(26)
    v_mfma_f32_16x16x32_bf16 v[16:19], a[84:87], v[116:119], v[16:19]
    s_waitcnt vmcnt(25)
    v_mfma_f32_16x16x32_bf16 v[16:19], a[88:91], v[120:123], v[16:19]
    s_waitcnt vmcnt(24)
    v_mfma_f32_16x16x32_bf16 v[16:19], a[92:95], v[124:127], v[16:19]
    s_waitcnt vmcnt(23)
    v_mfma_f32_16x16x32_bf16 v[16:19], a[96:99], v[128:131], v[16:19]
    s_waitcnt vmcnt(22)
    v_mfma_f32_16x16x32_bf16 v[16:19], a[100:103], v[132:135], v[16:19]
    s_waitcnt vmcnt(21)
    v_mfma_f32_16x16x32_bf16 v[16:19], a[104:107], v[136:139], v[16:19]
    s_waitcnt vmcnt(19)
    v_mfma_f32_16x16x32_bf16 v[16:19], a[108:111], v[140:143], v[16:19]
    v_max_u32 v36, v100, v101
    v_cmp_eq_u32 vcc, -1, v36
    s_nop 0
    s_or_b32 s10, vcc_lo, vcc_hi
    s_or_b32 s10, s10, s19
    s_waitcnt vmcnt(18)
    v_mfma_f32_16x16x32_bf16 v[16:19], a[112:115], v[144:147], v[16:19]
    s_waitcnt vmcnt(17)
    v_mfma_f32_16x16x32_bf16 v[16:19], a[116:119], v[148:151], v[16:19]
    s_waitcnt vmcnt(16)
    v_mfma_f32_16x16x32_bf16 v[16:19], a[120:123], v[152:155], v[16:19]
    s_waitcnt vmcnt(15)
    v_mfma_f32_16x16x32_bf16 v[16:19], a[124:127], v[156:159], v[16:19]
    s_waitcnt vmcnt(14)
    v_mfma_f32_16x16x32_bf16 v[16:19], a[128:131], v[160:163], v[16:19]
    s_waitcnt vmcnt(13)
    v_mfma_f32_16x16x32_bf16 v[16:19], a[132:135], v[164:167], v[16:19]
    s_waitcnt vmcnt(12)
    v_mfma_f32_16x16x32_bf16 v[16:19], a[136:139], v[168:171], v[16:19]
    s_waitcnt vmcnt(11)
    v_mfma_f32_16x16x32_bf16 v[16:19], a[140:143], v[172:175], v[16:19]
    s_waitcnt vmcnt(10)
    v_mfma_f32_16x16x32_bf16 v[16:19], a[144:147], v[176:179], v[16:19]
    s_waitcnt vmcnt(9)
    v_mfma_f32_16x16x32_bf16 v[16:19], a[148:151], v[180:183], v[16:19]
    s_waitcnt vmcnt(8)
    v_mfma_f32_16x16x32_bf16 v[16:19], a[152:155], v[184:187], v[16:19]
    s_waitcnt vmcnt(7)
    v_mfma_f32_16x16x32_bf16 v[16:19], a[156:159], v[188:191], v[16:19]
    s_waitcnt vmcnt(6)
    v_mfma_f32_16x16x32_bf16 v[16:19], a[160:163], v[192:195], v[16:19]
    s_waitcnt vmcnt(5)
    v_mfma_f32_16x16x32_bf16 v[16:19], a[164:167], v[196:199], v[16:19]
    s_waitcnt vmcnt(4)
    v_mfma_f32_16x16x32_bf16 v[16:19], a[0:3], v[200:203], v[16:19]
    s_waitcnt vmcnt(3)
    v_mfma_f32_16x16x32_bf16 v[16:19], a[4:7], v[204:207], v[16:19]
    s_waitcnt vmcnt(2)
    v_mfma_f32_16x16x32_bf16 v[16:19], a[8:11], v[208:211], v[16:19]
    s_waitcnt vmcnt(1)
    v_mfma_f32_16x16x32_bf16 v[16:19], a[12:15], v[212:215], v[16:19]
    s_cmp_lg_u32 s10, 0
    s_cbranch_scc1 L_notready
L_send:
    s_nop 5
    buffer_store_dwordx4 v[16:19], v1, s[48:51], s14 offen
L_slice:
    buffer_load_dwordx4 v[52:55], v3, s[48:51], s13 offen sc1
    v_max_f32_dpp v36, v100, v100 row_ror:8 row_mask:0xf bank_mask:0xf
    v_mov_b32 v37, v36
    s_nop 1
    v_permlane16_swap_b32 v36, v37
    v_max_f32 v36, v36, v37
    v_mov_b32 v37, v36
    s_nop 1
    v_permlane32_swap_b32 v36, v37
    v_max_f32 v36, v36, v37
    v_sub_f32 v42, v100, v36
    v_exp_f32 v42, v42
    buffer_load_dwordx4 v[56:59], v3, s[48:51], s13 offen sc1
    v_mul_f32 v38, v42, v101
    s_nop 1
    v_add_f32_dpp v36, v38, v38 row_ror:8 row_mask:0xf bank_mask:0xf
    v_mov_b32 v37, v36
    s_nop 1
    v_permlane16_swap_b32 v36, v37
    v_add_f32 v36, v36, v37
    v_mov_b32 v37, v36
    s_nop 1
    v_permlane32_swap_b32 v36, v37
    v_add_f32 v36, v36, v37
    v_rcp_f32 v36, v36
    s_nop 0
    v_mul_f32 v42, v42, v36
L_poll:
    buffer_load_dwordx4 v[20:23], v3, s[48:51], s13 offen sc1
    s_waitcnt vmcnt(2)
    v_max3_u32 v36, v52, v53, v54
    v_max_u32 v36, v36, v55
    v_cmp_eq_u32 vcc, -1, v36
    v_pk_mul_f32 v[60:61], v[52:53], v[42:43] op_sel_hi:[1,0]
    v_pk_mul_f32 v[62:63], v[54:55], v[42:43] op_sel_hi:[1,0]
    s_cbranch_vccz L_fin
    buffer_load_dwordx4 v[52:55], v3, s[48:51], s13 offen sc1
    s_waitcnt vmcnt(2)
    v_max3_u32 v36, v56, v57, v58
    v_max_u32 v36, v36, v59
    v_cmp_eq_u32 vcc, -1, v36
    v_pk_mul_f32 v[60:61], v[56:57], v[42:43] op_sel_hi:[1,0]
    v_pk_mul_f32 v[62:63], v[58:59], v[42:43] op_sel_hi:[1,0]
    s_cbranch_vccz L_fin
    buffer_load_dwordx4 v[56:59], v3, s[48:51], s13 offen sc1
    s_sub_u32 s21, s21, 1
    s_cbranch_scc1 L_fin
    s_waitcnt vmcnt(2)
    v_max3_u32 v36, v20, v21, v22
    v_max_u32 v36, v36, v23
    v_cmp_eq_u32 vcc, -1, v36
    v_pk_mul_f32 v[60:61], v[20:21], v[42:43] op_sel_hi:[1,0]
    v_pk_mul_f32 v[62:63], v[22:23], v[42:43] op_sel_hi:[1,0]
    s_cbranch_vccnz L_poll
L_fin:
    v_permlane32_swap_b32 v60, v61
    v_permlane32_swap_b32 v62, v63
    v_add_f32 v60, v60, v61
    v_add_f32 v62, v62, v63
    s_cmp_lg_u32 s11, 0
    s_nop 0
    v_permlane16_swap_b32 v60, v62
    v_add_f32 v60, v60, v62
    s_nop 1
    v_add_f32_dpp v60, v60, v60 row_ror:8 row_mask:0xf bank_mask:0xf
    s_mov_b64 exec, s[70:71]
    v_cvt_pk_bf16_f32 v60, v60, v60
    buffer_store_short v60, v102, s[44:47], s20 offen
    s_cbranch_scc1 L_more
L_exit:
    s_endpgm
L_notready:
    s_nop 7
    s_movk_i32 s17, 0x101
    s_cmp_lg_u32 s19, 0
    s_cbranch_scc1 L_handover
L_mlpoll:
    buffer_load_dwordx2 v[100:101], v6, s[48:51], s15 offen sc1
    s_waitcnt vmcnt(0)
    v_max_u32 v36, v100, v101
    v_cmp_eq_u32 vcc, -1, v36
    s_cbranch_vccz L_send
    s_sub_u32 s21, s21, 1
    s_cbranch_scc1 L_exit
    s_and_b32 s4, s21, 7
    s_cbranch_scc1 L_mlpoll
    v_mov_b32 v36, s18
    global_load_dword v36, v36, s[52:53] offset:128 sc1
    s_waitcnt vmcnt(0)
    v_readfirstlane_b32 s10, v36
    s_nop 0
    s_cmp_eq_u32 s10, 0
    s_cbranch_scc1 L_mlpoll
    s_mov_b32 s17, 1
L_handover:
    s_bitset1_b32 s14, 22
    buffer_store_dwordx4 v[16:19], v1, s[48:51], s14 offen sc1
    s_lshl_b32 s17, s17, s23
    s_add_u32 s4, s18, 128
    s_waitcnt vmcnt(0)
    s_atomic_or s17, s[52:53], s4
    s_waitcnt lgkmcnt(0)
    s_cmp_lg_u32 s23, 0
    s_cbranch_scc1 L_exit
L_collect:
    v_mov_b32 v36, s18
    global_load_dword v36, v36, s[52:53] offset:128 sc1
    s_waitcnt vmcnt(0)
    v_readfirstlane_b32 s10, v36
    s_sub_u32 s21, s21, 1
    s_cbranch_scc1 L_exit
    s_and_b32 s4, s10, 0xff
    s_cmp_lg_u32 s4, 0xff
    s_cbranch_scc1 L_collect
    v_lshrrev_b32 v37, 3, v0
    v_add_u32 v37, 8, v37
    v_lshrrev_b32 v36, v37, v36
    v_and_b32 v36, 1, v36
    v_lshl_or_b32 v6, v36, 22, v6
    v_or_b32 v3, 0x400000, v3
    s_mov_b32 s11, 8
L_more:
    s_mov_b64 exec, -1
    s_mov_b32 s21, 262144
    s_sub_u32 s11, s11, 1
    s_lshl_b32 s13, s11, 10
    s_add_u32 s13, s13, s12
    s_and_b32 s15, s11, 4
    s_lshl_b32 s15, s15, 4
    s_add_u32 s15, s15, s6
    s_lshl_b32 s20, s11, 6
    s_add_u32 s20, s20, s5
    buffer_load_dwordx2 v[100:101], v6, s[48:51], s15 offen sc1
    s_waitcnt vmcnt(0)
    s_branch L_slice
L_ml_remote:
    s_bitset1_b32 s9, 22
    buffer_store_dwordx2 v[40:41], v5, s[48:51], s9 offen sc1
    s_branch L_ml_sent
.section .rodata,"a"
.p2align 6
.amdhsa_kernel standalone__tree_speculative_verify_tree_attention_over_candidate_token_tree__decode_kernel
  .amdhsa_next_free_vgpr 384
  .amdhsa_next_free_sgpr 80
  .amdhsa_accum_offset 216
  .amdhsa_group_segment_fixed_size 0
  .amdhsa_kernarg_size 72
  .amdhsa_user_sgpr_count 2
  .amdhsa_user_sgpr_kernarg_segment_ptr 1
  .amdhsa_system_sgpr_workgroup_id_x 1
  .amdhsa_float_denorm_mode_32 3
.end_amdhsa_kernel
```
